```python
import torch

def _softmax(x, axis=-1):
    return torch.softmax(x, dim=axis)
def _gelu(x):
    return torch.nn.functional.gelu(x, approximate="tanh")
def _silu(x):
    return torch.nn.functional.silu(x)
def _sigmoid(x):
    return torch.sigmoid(x)
def _layernorm(x, axis=-1, eps=1e-5):
    m = x.mean(dim=axis, keepdim=True)
    v = x.var(dim=axis, keepdim=True, unbiased=False)
    return (x - m) / torch.sqrt(v + eps)
def _scatter_add(tgt, idx, src, axis=0):
    return tgt.clone().index_add_(axis, idx, src)
def _segment_sum(src, seg, n):
    out = torch.zeros((n,) + src.shape[1:], dtype=src.dtype)
    return out.index_add_(0, seg, src)
def _pad(x, pw):
    flat = tuple(v for pair in reversed(pw) for v in pair)
    return torch.nn.functional.pad(x, flat)

kernel_name = 'concat_heads__mha_block_cached__gqa_block_cached__near_ridge'

def setup_inputs():

    _w = (lambda a: (lambda t: t.to(torch.bfloat16) if t.is_floating_point() else t)(torch.as_tensor(a)))
    def _A_setup():
        B, Sq, D = 32, 32, 512
        H, Sk, Dh = 32, 32, 128
        return {
            "x": _w((lambda *s: torch.randn(*s, dtype=torch.bfloat16) * 0.8)(B, Sq, D)),
            "k_cache": _w((lambda *s: torch.randn(*s, dtype=torch.bfloat16) * 0.8)(B, H, Sk, Dh)),
            "v_cache": _w((lambda *s: torch.randn(*s, dtype=torch.bfloat16) * 0.05)(B, H, Sk, Dh)),
            "wq": _w((lambda *s: torch.randn(*s, dtype=torch.bfloat16) * 0.8)(D, H * Dh) * (D ** -0.5)),
            "wo": _w((lambda *s: torch.randn(*s, dtype=torch.bfloat16) * 0.05)(H * Dh, D) * ((H * Dh) ** -0.5)),
        }
    _A_in = _A_setup()

    def _B_setup():
        B, Sq, D = 32, 32, 512
        Hq, Hkv, Sk, Dh = 32, 32, 32, 128
        assert Hq % Hkv == 0, (Hq, Hkv)
        return {
            "x": _w((lambda *s: torch.randn(*s, dtype=torch.bfloat16) * 0.8)(B, Sq, D)),
            "k_cache": _w((lambda *s: torch.randn(*s, dtype=torch.bfloat16) * 0.8)(B, Hkv, Sk, Dh)),
            "v_cache": _w((lambda *s: torch.randn(*s, dtype=torch.bfloat16) * 0.05)(B, Hkv, Sk, Dh)),
            "wq": _w((lambda *s: torch.randn(*s, dtype=torch.bfloat16) * 0.8)(D, Hq * Dh) * (D ** -0.5)),
            "wo": _w((lambda *s: torch.randn(*s, dtype=torch.bfloat16) * 0.05)(Hq * Dh, D) * ((Hq * Dh) ** -0.5)),
        }
    _B_in = _B_setup()

    return {
        "A_x": _A_in["x"],
        "A_k_cache": _A_in["k_cache"],
        "A_v_cache": _A_in["v_cache"],
        "A_wq": _A_in["wq"],
        "A_wo": _A_in["wo"],
        "B_x": _B_in["x"],
        "B_k_cache": _B_in["k_cache"],
        "B_v_cache": _B_in["v_cache"],
        "B_wq": _B_in["wq"],
        "B_wo": _B_in["wo"],
    }

def reference(A_x, A_k_cache, A_v_cache, A_wq, A_wo, B_x, B_k_cache, B_v_cache, B_wq, B_wo):
    def _A_ref(x, k_cache, v_cache, wq, wo):
        B, Sq, D = x.shape
        H, Dh = 32, 128
        q = (lambda x, *d: x.permute(*d))((x @ wq).reshape(B, Sq, H, Dh), 0, 2, 1, 3)
        scores = torch.einsum("bhqd,bhkd->bhqk", q, k_cache) * (Dh ** -0.5)
        p = _softmax(scores, axis=-1)
        o = torch.einsum("bhqk,bhkd->bhqd", p, v_cache)
        return (lambda x, *d: x.permute(*d))(o, 0, 2, 1, 3).reshape(B, Sq, H * Dh) @ wo

    def _B_ref(x, k_cache, v_cache, wq, wo):
        B, Sq, D = x.shape
        Hq, Dh = 32, 128
        Hkv = k_cache.shape[1]
        rep = Hq // Hkv
        q = (lambda x, *d: x.permute(*d))((x @ wq).reshape(B, Sq, Hq, Dh), 0, 2, 1, 3)
        k = (lambda x, n, axis: torch.repeat_interleave(x, n, dim=axis))(k_cache, rep, axis=1)
        v = (lambda x, n, axis: torch.repeat_interleave(x, n, dim=axis))(v_cache, rep, axis=1)
        scores = torch.einsum("bhqd,bhkd->bhqk", q, k) * (Dh ** -0.5)
        p = _softmax(scores, axis=-1)
        o = torch.einsum("bhqk,bhkd->bhqd", p, v)
        return (lambda x, *d: x.permute(*d))(o, 0, 2, 1, 3).reshape(B, Sq, Hq * Dh) @ wo

    a = _A_ref(A_x, A_k_cache, A_v_cache, A_wq, A_wo)
    b = _B_ref(B_x, B_k_cache, B_v_cache, B_wq, B_wo)
    return torch.concatenate([a, b], axis=-1)
```

```asm
; @launch kernel=attn_k1_kernel grid=(256,1,1) block=(512,1,1) lds=163840
.amdgcn_target "amdgcn-amd-amdhsa--gfx950"
.text
.globl attn_k1_kernel
.p2align 8
.type attn_k1_kernel,@function
attn_k1_kernel:
    s_cmp_ge_u32 s2, 256
    s_cbranch_scc1 K1_DONE
    s_load_dwordx16 s[16:31], s[0:1], 0
    s_load_dwordx4 s[32:35], s[0:1], 64
    s_load_dwordx2 s[36:37], s[0:1], 80
    s_load_dwordx2 s[38:39], s[0:1], 96
    s_load_dwordx2 s[4:5], s[0:1], 88
    s_mov_b32 s6, 256
    s_mov_b32 s7, 0x20000
    s_and_b32 s44, s2, 7
    s_lshr_b32 s45, s2, 3
    s_lshr_b32 s40, s44, 2
    s_and_b32 s44, s44, 3
    s_lshl_b32 s44, s44, 2
    s_and_b32 s41, s45, 3
    s_add_u32 s41, s41, s44
    s_lshr_b32 s42, s45, 2
    s_lshr_b32 s12, s2, 3
    v_lshrrev_b32 v1, 6, v0
    s_nop 0
    v_readfirstlane_b32 s43, v1
    v_and_b32 v1, 63, v0
    s_nop 2
    s_cmp_ge_u32 s43, 4
    s_cbranch_scc1 K1_FAST
    s_or_b32 s44, s2, s43
    s_cmp_lg_u32 s44, 0
    s_cbranch_scc1 F_NONONCE
    s_memrealtime s[44:45]
    s_waitcnt lgkmcnt(0)
    s_or_b32 s44, s44, 1
    v_mov_b32 v2, s44
    v_mov_b32 v3, s45
    v_mov_b32 v4, 0
    buffer_store_dwordx2 v[2:3], v4, s[4:7], 0 offen sc1
F_NONONCE:
    s_waitcnt lgkmcnt(0)
    s_cmp_ge_u32 s12, 1
    s_cbranch_scc1 C_NOPF
    s_getpc_b64 s[92:93]
C_PFBASE:
    v_lshlrev_b32 v14, 7, v1
    s_lshl_b32 s44, s43, 13
    v_add_u32 v14, s44, v14
    s_mov_b32 s44, K1_DONE-C_PFBASE-4
    v_min_u32 v14, s44, v14
    s_nop 1
    global_load_dword v14, v14, s[92:93]
C_NOPF:
    v_and_b32 v16, 15, v1
    v_lshrrev_b32 v17, 5, v1
    v_bfe_u32 v18, v1, 4, 1
    v_lshrrev_b32 v19, 2, v16
    v_and_b32 v20, 3, v1
    v_and_b32 v21, 1, v20
    v_lshlrev_b32 v21, 4, v21
    v_lshrrev_b32 v22, 1, v20
    v_lshlrev_b32 v22, 3, v22
    v_or_b32 v21, v21, v22
    v_lshlrev_b32 v22, 5, v18
    v_or_b32 v21, v21, v22
    v_lshlrev_b32 v22, 3, v17
    v_add_u32 v22, v22, v19
    v_lshlrev_b32 v22, 9, v22
    v_add_u32 v21, v21, v22
    s_lshr_b32 s44, s43, 1
    s_lshl_b32 s44, s44, 8
    v_add_u32 v21, s44, v21
    v_xor_b32 v22, 0, v19
    v_lshlrev_b32 v22, 6, v22
    v_add_u32 v2, v21, v22
    v_add_u32 v2, 65536, v2
    v_xor_b32 v22, 1, v19
    v_lshlrev_b32 v22, 6, v22
    v_add_u32 v3, v21, v22
    v_add_u32 v3, 65536, v3
    v_xor_b32 v22, 2, v19
    v_lshlrev_b32 v22, 6, v22
    v_add_u32 v4, v21, v22
    v_add_u32 v4, 65536, v4
    v_xor_b32 v22, 3, v19
    v_lshlrev_b32 v22, 6, v22
    v_add_u32 v5, v21, v22
    v_add_u32 v5, 65536, v5
    v_and_b32 v21, 31, v1
    v_bfe_u32 v22, v1, 1, 3
    v_xor_b32 v22, v22, v17
    v_lshlrev_b32 v21, 7, v21
    s_and_b32 s44, s43, 1
    s_lshl_b32 s44, s44, 13
    s_add_u32 s44, s44, 131072
    v_add_u32 v21, s44, v21
    v_xor_b32 v23, 0, v22
    v_lshlrev_b32 v23, 4, v23
    v_add_u32 v10, v21, v23
    v_xor_b32 v23, 2, v22
    v_lshlrev_b32 v23, 4, v23
    v_add_u32 v11, v21, v23
    v_xor_b32 v23, 4, v22
    v_lshlrev_b32 v23, 4, v23
    v_add_u32 v12, v21, v23
    v_xor_b32 v23, 6, v22
    v_lshlrev_b32 v23, 4, v23
    v_add_u32 v13, v21, v23
    s_and_b32 s44, s43, 1
    s_lshl_b32 s44, s44, 19
    s_lshr_b32 s45, s43, 1
    s_lshl_b32 s45, s45, 13
    s_add_u32 s70, s44, s45
    s_add_u32 s71, s70, 262144
    s_add_u32 s72, s70, 4096
    s_add_u32 s73, s71, 4096
    s_mov_b32 s74, 0
    s_cmp_eq_u32 s43, 1
    s_cselect_b32 s74, 16384, s74
    s_cmp_eq_u32 s43, 2
    s_cselect_b32 s74, 32768, s74
    s_cmp_eq_u32 s43, 3
    s_cselect_b32 s74, 49152, s74
    s_mov_b32 s75, 65536
    s_cmp_eq_u32 s43, 1
    s_cselect_b32 s75, 81920, s75
    s_cmp_eq_u32 s43, 2
    s_cselect_b32 s75, 131072, s75
    s_cmp_eq_u32 s43, 3
    s_cselect_b32 s75, 98304, s75
    s_mov_b32 s76, 0x3e0293ee
    s_lshr_b32 s80, s41, 2
    s_and_b32 s81, s41, 3
    s_lshl_b32 s44, s80, 20
    s_lshl_b32 s45, s81, 8
    s_add_u32 s44, s44, s45
    s_add_u32 s48, s24, s44
    s_addc_u32 s49, s25, 0
    s_sub_u32 s50, 4194304, s44
    s_mov_b32 s51, 0x20000
    s_lshl_b32 s44, s40, 23
    s_lshl_b32 s45, s42, 20
    s_add_u32 s44, s44, s45
    s_lshl_b32 s45, s80, 16
    s_add_u32 s44, s44, s45
    s_add_u32 s52, s38, s44
    s_addc_u32 s53, s39, 0
    s_sub_u32 s54, 16777216, s44
    s_mov_b32 s55, 0x20000
    s_lshl_b32 s82, s40, 3
    s_add_u32 s82, s82, s42
    s_lshl_b32 s82, s82, 2
    s_add_u32 s82, s82, s81
    s_lshl_b32 s44, s82, 18
    s_add_u32 s44, s44, 33554432
    s_add_u32 s56, s38, s44
    s_addc_u32 s57, s39, 0
    s_sub_u32 s58, 50331648, s44
    s_mov_b32 s59, 0x20000
    s_lshl_b32 s44, s82, 7
    s_add_u32 s44, s44, 58720256
    s_add_u32 s60, s38, s44
    s_addc_u32 s61, s39, 0
    s_sub_u32 s62, 58851328, s44
    s_mov_b32 s63, 0x20000
    s_lshl_b32 s44, s42, 18
    s_lshl_b32 s45, s40, 10
    s_add_u32 s44, s44, s45
    s_lshl_b32 s45, s81, 8
    s_add_u32 s44, s44, s45
    s_add_u32 s64, s36, s44
    s_addc_u32 s65, s37, 0
    s_sub_u32 s66, 2097152, s44
    s_mov_b32 s67, 0x20000
    s_barrier
    ds_read_b128 v[48:51], v10
    ds_read_b64_tr_b16 v[16:17], v2
    ds_read_b64_tr_b16 v[18:19], v2 offset:2048
    ds_read_b128 v[52:55], v10 offset:4096
    ds_read_b64_tr_b16 v[20:21], v3
    ds_read_b64_tr_b16 v[22:23], v3 offset:2048
    ds_read_b64_tr_b16 v[24:25], v4
    ds_read_b64_tr_b16 v[26:27], v4 offset:2048
    ds_read_b64_tr_b16 v[28:29], v5
    ds_read_b64_tr_b16 v[30:31], v5 offset:2048
    s_waitcnt lgkmcnt(7)
    v_mfma_f32_32x32x16_bf16 v[128:143], v[16:19], v[48:51], 0
    ds_read_b128 v[56:59], v11
    ds_read_b64_tr_b16 v[32:33], v2 offset:8192
    s_waitcnt lgkmcnt(8)
    v_mfma_f32_32x32x16_bf16 v[192:207], v[16:19], v[52:55], 0
    ds_read_b64_tr_b16 v[34:35], v2 offset:10240
    ds_read_b128 v[60:63], v11 offset:4096
    s_waitcnt lgkmcnt(8)
    v_mfma_f32_32x32x16_bf16 v[144:159], v[20:23], v[48:51], 0
    ds_read_b64_tr_b16 v[36:37], v3 offset:8192
    ds_read_b64_tr_b16 v[38:39], v3 offset:10240
    v_mfma_f32_32x32x16_bf16 v[208:223], v[20:23], v[52:55], 0
    ds_read_b64_tr_b16 v[40:41], v4 offset:8192
    ds_read_b64_tr_b16 v[42:43], v4 offset:10240
    s_waitcnt lgkmcnt(10)
    v_mfma_f32_32x32x16_bf16 v[160:175], v[24:27], v[48:51], 0
    ds_read_b64_tr_b16 v[44:45], v5 offset:8192
    ds_read_b64_tr_b16 v[46:47], v5 offset:10240
    v_mfma_f32_32x32x16_bf16 v[224:239], v[24:27], v[52:55], 0
    s_waitcnt lgkmcnt(10)
    v_mfma_f32_32x32x16_bf16 v[176:191], v[28:31], v[48:51], 0
    v_mfma_f32_32x32x16_bf16 v[240:255], v[28:31], v[52:55], 0
    s_waitcnt lgkmcnt(0)
    s_barrier
    v_mfma_f32_32x32x16_bf16 v[128:143], v[32:35], v[56:59], v[128:143]
    ds_read_b128 v[48:51], v12
    ds_read_b64_tr_b16 v[16:17], v2 offset:16384
    v_mfma_f32_32x32x16_bf16 v[192:207], v[32:35], v[60:63], v[192:207]
    ds_read_b64_tr_b16 v[18:19], v2 offset:18432
    ds_read_b128 v[52:55], v12 offset:4096
    v_mfma_f32_32x32x16_bf16 v[144:159], v[36:39], v[56:59], v[144:159]
    ds_read_b64_tr_b16 v[20:21], v3 offset:16384
    ds_read_b64_tr_b16 v[22:23], v3 offset:18432
    v_mfma_f32_32x32x16_bf16 v[208:223], v[36:39], v[60:63], v[208:223]
    ds_read_b64_tr_b16 v[24:25], v4 offset:16384
    ds_read_b64_tr_b16 v[26:27], v4 offset:18432
    v_mfma_f32_32x32x16_bf16 v[160:175], v[40:43], v[56:59], v[160:175]
    ds_read_b64_tr_b16 v[28:29], v5 offset:16384
    ds_read_b64_tr_b16 v[30:31], v5 offset:18432
    v_mfma_f32_32x32x16_bf16 v[224:239], v[40:43], v[60:63], v[224:239]
    v_mfma_f32_32x32x16_bf16 v[176:191], v[44:47], v[56:59], v[176:191]
    v_mfma_f32_32x32x16_bf16 v[240:255], v[44:47], v[60:63], v[240:255]
    s_waitcnt lgkmcnt(7)
    v_mfma_f32_32x32x16_bf16 v[128:143], v[16:19], v[48:51], v[128:143]
    ds_read_b128 v[56:59], v13
    ds_read_b64_tr_b16 v[32:33], v2 offset:24576
    s_waitcnt lgkmcnt(8)
    v_mfma_f32_32x32x16_bf16 v[192:207], v[16:19], v[52:55], v[192:207]
    ds_read_b64_tr_b16 v[34:35], v2 offset:26624
    ds_read_b128 v[60:63], v13 offset:4096
    s_waitcnt lgkmcnt(8)
    v_mfma_f32_32x32x16_bf16 v[144:159], v[20:23], v[48:51], v[144:159]
    ds_read_b64_tr_b16 v[36:37], v3 offset:24576
    ds_read_b64_tr_b16 v[38:39], v3 offset:26624
    v_mfma_f32_32x32x16_bf16 v[208:223], v[20:23], v[52:55], v[208:223]
    ds_read_b64_tr_b16 v[40:41], v4 offset:24576
    ds_read_b64_tr_b16 v[42:43], v4 offset:26624
    s_waitcnt lgkmcnt(10)
    v_mfma_f32_32x32x16_bf16 v[160:175], v[24:27], v[48:51], v[160:175]
    ds_read_b64_tr_b16 v[44:45], v5 offset:24576
    ds_read_b64_tr_b16 v[46:47], v5 offset:26624
    v_mfma_f32_32x32x16_bf16 v[224:239], v[24:27], v[52:55], v[224:239]
    s_waitcnt lgkmcnt(10)
    v_mfma_f32_32x32x16_bf16 v[176:191], v[28:31], v[48:51], v[176:191]
    v_mfma_f32_32x32x16_bf16 v[240:255], v[28:31], v[52:55], v[240:255]
    s_waitcnt lgkmcnt(0)
    s_barrier
    v_mfma_f32_32x32x16_bf16 v[128:143], v[32:35], v[56:59], v[128:143]
    ds_read_b128 v[48:51], v10 offset:16384
    ds_read_b64_tr_b16 v[16:17], v2 offset:32768
    v_mfma_f32_32x32x16_bf16 v[192:207], v[32:35], v[60:63], v[192:207]
    ds_read_b64_tr_b16 v[18:19], v2 offset:34816
    ds_read_b128 v[52:55], v10 offset:20480
    v_mfma_f32_32x32x16_bf16 v[144:159], v[36:39], v[56:59], v[144:159]
    ds_read_b64_tr_b16 v[20:21], v3 offset:32768
    ds_read_b64_tr_b16 v[22:23], v3 offset:34816
    v_mfma_f32_32x32x16_bf16 v[208:223], v[36:39], v[60:63], v[208:223]
    ds_read_b64_tr_b16 v[24:25], v4 offset:32768
    ds_read_b64_tr_b16 v[26:27], v4 offset:34816
    v_mfma_f32_32x32x16_bf16 v[160:175], v[40:43], v[56:59], v[160:175]
    ds_read_b64_tr_b16 v[28:29], v5 offset:32768
    ds_read_b64_tr_b16 v[30:31], v5 offset:34816
    v_mfma_f32_32x32x16_bf16 v[224:239], v[40:43], v[60:63], v[224:239]
    v_mfma_f32_32x32x16_bf16 v[176:191], v[44:47], v[56:59], v[176:191]
    v_mfma_f32_32x32x16_bf16 v[240:255], v[44:47], v[60:63], v[240:255]
    s_waitcnt lgkmcnt(7)
    v_mfma_f32_32x32x16_bf16 v[128:143], v[16:19], v[48:51], v[128:143]
    ds_read_b128 v[56:59], v11 offset:16384
    ds_read_b64_tr_b16 v[32:33], v2 offset:40960
    s_waitcnt lgkmcnt(8)
    v_mfma_f32_32x32x16_bf16 v[192:207], v[16:19], v[52:55], v[192:207]
    ds_read_b64_tr_b16 v[34:35], v2 offset:43008
    ds_read_b128 v[60:63], v11 offset:20480
    s_waitcnt lgkmcnt(8)
    v_mfma_f32_32x32x16_bf16 v[144:159], v[20:23], v[48:51], v[144:159]
    ds_read_b64_tr_b16 v[36:37], v3 offset:40960
    ds_read_b64_tr_b16 v[38:39], v3 offset:43008
    v_mfma_f32_32x32x16_bf16 v[208:223], v[20:23], v[52:55], v[208:223]
    ds_read_b64_tr_b16 v[40:41], v4 offset:40960
    ds_read_b64_tr_b16 v[42:43], v4 offset:43008
    s_waitcnt lgkmcnt(10)
    v_mfma_f32_32x32x16_bf16 v[160:175], v[24:27], v[48:51], v[160:175]
    ds_read_b64_tr_b16 v[44:45], v5 offset:40960
    ds_read_b64_tr_b16 v[46:47], v5 offset:43008
    v_mfma_f32_32x32x16_bf16 v[224:239], v[24:27], v[52:55], v[224:239]
    s_waitcnt lgkmcnt(10)
    v_mfma_f32_32x32x16_bf16 v[176:191], v[28:31], v[48:51], v[176:191]
    v_mfma_f32_32x32x16_bf16 v[240:255], v[28:31], v[52:55], v[240:255]
    s_waitcnt lgkmcnt(0)
    s_barrier
    v_mfma_f32_32x32x16_bf16 v[128:143], v[32:35], v[56:59], v[128:143]
    ds_read_b128 v[48:51], v12 offset:16384
    ds_read_b64_tr_b16 v[16:17], v2 offset:49152
    v_mfma_f32_32x32x16_bf16 v[192:207], v[32:35], v[60:63], v[192:207]
    ds_read_b64_tr_b16 v[18:19], v2 offset:51200
    ds_read_b128 v[52:55], v12 offset:20480
    v_mfma_f32_32x32x16_bf16 v[144:159], v[36:39], v[56:59], v[144:159]
    ds_read_b64_tr_b16 v[20:21], v3 offset:49152
    ds_read_b64_tr_b16 v[22:23], v3 offset:51200
    v_mfma_f32_32x32x16_bf16 v[208:223], v[36:39], v[60:63], v[208:223]
    ds_read_b64_tr_b16 v[24:25], v4 offset:49152
    ds_read_b64_tr_b16 v[26:27], v4 offset:51200
    v_mfma_f32_32x32x16_bf16 v[160:175], v[40:43], v[56:59], v[160:175]
    ds_read_b64_tr_b16 v[28:29], v5 offset:49152
    ds_read_b64_tr_b16 v[30:31], v5 offset:51200
    v_mfma_f32_32x32x16_bf16 v[224:239], v[40:43], v[60:63], v[224:239]
    v_mfma_f32_32x32x16_bf16 v[176:191], v[44:47], v[56:59], v[176:191]
    v_mfma_f32_32x32x16_bf16 v[240:255], v[44:47], v[60:63], v[240:255]
    s_waitcnt lgkmcnt(7)
    v_mfma_f32_32x32x16_bf16 v[128:143], v[16:19], v[48:51], v[128:143]
    ds_read_b128 v[56:59], v13 offset:16384
    ds_read_b64_tr_b16 v[32:33], v2 offset:57344
    s_waitcnt lgkmcnt(8)
    v_mfma_f32_32x32x16_bf16 v[192:207], v[16:19], v[52:55], v[192:207]
    ds_read_b64_tr_b16 v[34:35], v2 offset:59392
    ds_read_b128 v[60:63], v13 offset:20480
    s_waitcnt lgkmcnt(8)
    v_mfma_f32_32x32x16_bf16 v[144:159], v[20:23], v[48:51], v[144:159]
    ds_read_b64_tr_b16 v[36:37], v3 offset:57344
    ds_read_b64_tr_b16 v[38:39], v3 offset:59392
    v_mfma_f32_32x32x16_bf16 v[208:223], v[20:23], v[52:55], v[208:223]
    ds_read_b64_tr_b16 v[40:41], v4 offset:57344
    ds_read_b64_tr_b16 v[42:43], v4 offset:59392
    s_waitcnt lgkmcnt(10)
    v_mfma_f32_32x32x16_bf16 v[160:175], v[24:27], v[48:51], v[160:175]
    ds_read_b64_tr_b16 v[44:45], v5 offset:57344
    ds_read_b64_tr_b16 v[46:47], v5 offset:59392
    v_mfma_f32_32x32x16_bf16 v[224:239], v[24:27], v[52:55], v[224:239]
    s_waitcnt lgkmcnt(10)
    v_mfma_f32_32x32x16_bf16 v[176:191], v[28:31], v[48:51], v[176:191]
    v_mfma_f32_32x32x16_bf16 v[240:255], v[28:31], v[52:55], v[240:255]
    s_waitcnt lgkmcnt(0)
    s_barrier
    v_mfma_f32_32x32x16_bf16 v[128:143], v[32:35], v[56:59], v[128:143]
    ds_read_b128 v[48:51], v10
    ds_read_b64_tr_b16 v[16:17], v2
    v_mfma_f32_32x32x16_bf16 v[192:207], v[32:35], v[60:63], v[192:207]
    ds_read_b64_tr_b16 v[18:19], v2 offset:2048
    ds_read_b128 v[52:55], v10 offset:4096
    v_mfma_f32_32x32x16_bf16 v[144:159], v[36:39], v[56:59], v[144:159]
    ds_read_b64_tr_b16 v[20:21], v3
    ds_read_b64_tr_b16 v[22:23], v3 offset:2048
    v_mfma_f32_32x32x16_bf16 v[208:223], v[36:39], v[60:63], v[208:223]
    ds_read_b64_tr_b16 v[24:25], v4
    ds_read_b64_tr_b16 v[26:27], v4 offset:2048
    v_mfma_f32_32x32x16_bf16 v[160:175], v[40:43], v[56:59], v[160:175]
    ds_read_b64_tr_b16 v[28:29], v5
    ds_read_b64_tr_b16 v[30:31], v5 offset:2048
    v_mfma_f32_32x32x16_bf16 v[224:239], v[40:43], v[60:63], v[224:239]
    v_mfma_f32_32x32x16_bf16 v[176:191], v[44:47], v[56:59], v[176:191]
    v_mfma_f32_32x32x16_bf16 v[240:255], v[44:47], v[60:63], v[240:255]
    s_waitcnt lgkmcnt(7)
    v_mfma_f32_32x32x16_bf16 v[128:143], v[16:19], v[48:51], v[128:143]
    ds_read_b128 v[56:59], v11
    ds_read_b64_tr_b16 v[32:33], v2 offset:8192
    s_waitcnt lgkmcnt(8)
    v_mfma_f32_32x32x16_bf16 v[192:207], v[16:19], v[52:55], v[192:207]
    ds_read_b64_tr_b16 v[34:35], v2 offset:10240
    ds_read_b128 v[60:63], v11 offset:4096
    s_waitcnt lgkmcnt(8)
    v_mfma_f32_32x32x16_bf16 v[144:159], v[20:23], v[48:51], v[144:159]
    ds_read_b64_tr_b16 v[36:37], v3 offset:8192
    ds_read_b64_tr_b16 v[38:39], v3 offset:10240
    v_mfma_f32_32x32x16_bf16 v[208:223], v[20:23], v[52:55], v[208:223]
    ds_read_b64_tr_b16 v[40:41], v4 offset:8192
    ds_read_b64_tr_b16 v[42:43], v4 offset:10240
    s_waitcnt lgkmcnt(10)
    v_mfma_f32_32x32x16_bf16 v[160:175], v[24:27], v[48:51], v[160:175]
    ds_read_b64_tr_b16 v[44:45], v5 offset:8192
    ds_read_b64_tr_b16 v[46:47], v5 offset:10240
    v_mfma_f32_32x32x16_bf16 v[224:239], v[24:27], v[52:55], v[224:239]
    s_waitcnt lgkmcnt(10)
    v_mfma_f32_32x32x16_bf16 v[176:191], v[28:31], v[48:51], v[176:191]
    v_mfma_f32_32x32x16_bf16 v[240:255], v[28:31], v[52:55], v[240:255]
    s_waitcnt lgkmcnt(0)
    s_barrier
    v_mfma_f32_32x32x16_bf16 v[128:143], v[32:35], v[56:59], v[128:143]
    ds_read_b128 v[48:51], v12
    ds_read_b64_tr_b16 v[16:17], v2 offset:16384
    v_mfma_f32_32x32x16_bf16 v[192:207], v[32:35], v[60:63], v[192:207]
    ds_read_b64_tr_b16 v[18:19], v2 offset:18432
    ds_read_b128 v[52:55], v12 offset:4096
    v_mfma_f32_32x32x16_bf16 v[144:159], v[36:39], v[56:59], v[144:159]
    ds_read_b64_tr_b16 v[20:21], v3 offset:16384
    ds_read_b64_tr_b16 v[22:23], v3 offset:18432
    v_mfma_f32_32x32x16_bf16 v[208:223], v[36:39], v[60:63], v[208:223]
    ds_read_b64_tr_b16 v[24:25], v4 offset:16384
    ds_read_b64_tr_b16 v[26:27], v4 offset:18432
    v_mfma_f32_32x32x16_bf16 v[160:175], v[40:43], v[56:59], v[160:175]
    ds_read_b64_tr_b16 v[28:29], v5 offset:16384
    ds_read_b64_tr_b16 v[30:31], v5 offset:18432
    v_mfma_f32_32x32x16_bf16 v[224:239], v[40:43], v[60:63], v[224:239]
    v_mfma_f32_32x32x16_bf16 v[176:191], v[44:47], v[56:59], v[176:191]
    v_mfma_f32_32x32x16_bf16 v[240:255], v[44:47], v[60:63], v[240:255]
    s_waitcnt lgkmcnt(7)
    v_mfma_f32_32x32x16_bf16 v[128:143], v[16:19], v[48:51], v[128:143]
    ds_read_b128 v[56:59], v13
    ds_read_b64_tr_b16 v[32:33], v2 offset:24576
    s_waitcnt lgkmcnt(8)
    v_mfma_f32_32x32x16_bf16 v[192:207], v[16:19], v[52:55], v[192:207]
    ds_read_b64_tr_b16 v[34:35], v2 offset:26624
    ds_read_b128 v[60:63], v13 offset:4096
    s_waitcnt lgkmcnt(8)
    v_mfma_f32_32x32x16_bf16 v[144:159], v[20:23], v[48:51], v[144:159]
    ds_read_b64_tr_b16 v[36:37], v3 offset:24576
    ds_read_b64_tr_b16 v[38:39], v3 offset:26624
    v_mfma_f32_32x32x16_bf16 v[208:223], v[20:23], v[52:55], v[208:223]
    ds_read_b64_tr_b16 v[40:41], v4 offset:24576
    ds_read_b64_tr_b16 v[42:43], v4 offset:26624
    s_waitcnt lgkmcnt(10)
    v_mfma_f32_32x32x16_bf16 v[160:175], v[24:27], v[48:51], v[160:175]
    ds_read_b64_tr_b16 v[44:45], v5 offset:24576
    ds_read_b64_tr_b16 v[46:47], v5 offset:26624
    v_mfma_f32_32x32x16_bf16 v[224:239], v[24:27], v[52:55], v[224:239]
    s_waitcnt lgkmcnt(10)
    v_mfma_f32_32x32x16_bf16 v[176:191], v[28:31], v[48:51], v[176:191]
    v_mfma_f32_32x32x16_bf16 v[240:255], v[28:31], v[52:55], v[240:255]
    s_waitcnt lgkmcnt(0)
    s_barrier
    v_mfma_f32_32x32x16_bf16 v[128:143], v[32:35], v[56:59], v[128:143]
    ds_read_b128 v[48:51], v10 offset:16384
    ds_read_b64_tr_b16 v[16:17], v2 offset:32768
    v_mfma_f32_32x32x16_bf16 v[192:207], v[32:35], v[60:63], v[192:207]
    ds_read_b64_tr_b16 v[18:19], v2 offset:34816
    ds_read_b128 v[52:55], v10 offset:20480
    v_mfma_f32_32x32x16_bf16 v[144:159], v[36:39], v[56:59], v[144:159]
    ds_read_b64_tr_b16 v[20:21], v3 offset:32768
    ds_read_b64_tr_b16 v[22:23], v3 offset:34816
    v_mfma_f32_32x32x16_bf16 v[208:223], v[36:39], v[60:63], v[208:223]
    ds_read_b64_tr_b16 v[24:25], v4 offset:32768
    ds_read_b64_tr_b16 v[26:27], v4 offset:34816
    v_mfma_f32_32x32x16_bf16 v[160:175], v[40:43], v[56:59], v[160:175]
    ds_read_b64_tr_b16 v[28:29], v5 offset:32768
    ds_read_b64_tr_b16 v[30:31], v5 offset:34816
    v_mfma_f32_32x32x16_bf16 v[224:239], v[40:43], v[60:63], v[224:239]
    v_mfma_f32_32x32x16_bf16 v[176:191], v[44:47], v[56:59], v[176:191]
    v_mfma_f32_32x32x16_bf16 v[240:255], v[44:47], v[60:63], v[240:255]
    s_waitcnt lgkmcnt(7)
    v_mfma_f32_32x32x16_bf16 v[128:143], v[16:19], v[48:51], v[128:143]
    ds_read_b128 v[56:59], v11 offset:16384
    ds_read_b64_tr_b16 v[32:33], v2 offset:40960
    s_waitcnt lgkmcnt(8)
    v_mfma_f32_32x32x16_bf16 v[192:207], v[16:19], v[52:55], v[192:207]
    ds_read_b64_tr_b16 v[34:35], v2 offset:43008
    ds_read_b128 v[60:63], v11 offset:20480
    s_waitcnt lgkmcnt(8)
    v_mfma_f32_32x32x16_bf16 v[144:159], v[20:23], v[48:51], v[144:159]
    ds_read_b64_tr_b16 v[36:37], v3 offset:40960
    ds_read_b64_tr_b16 v[38:39], v3 offset:43008
    v_mfma_f32_32x32x16_bf16 v[208:223], v[20:23], v[52:55], v[208:223]
    ds_read_b64_tr_b16 v[40:41], v4 offset:40960
    ds_read_b64_tr_b16 v[42:43], v4 offset:43008
    s_waitcnt lgkmcnt(10)
    v_mfma_f32_32x32x16_bf16 v[160:175], v[24:27], v[48:51], v[160:175]
    ds_read_b64_tr_b16 v[44:45], v5 offset:40960
    ds_read_b64_tr_b16 v[46:47], v5 offset:43008
    v_mfma_f32_32x32x16_bf16 v[224:239], v[24:27], v[52:55], v[224:239]
    s_waitcnt lgkmcnt(10)
    v_mfma_f32_32x32x16_bf16 v[176:191], v[28:31], v[48:51], v[176:191]
    v_mfma_f32_32x32x16_bf16 v[240:255], v[28:31], v[52:55], v[240:255]
    s_waitcnt lgkmcnt(0)
    s_barrier
    v_mfma_f32_32x32x16_bf16 v[128:143], v[32:35], v[56:59], v[128:143]
    ds_read_b128 v[48:51], v12 offset:16384
    ds_read_b64_tr_b16 v[16:17], v2 offset:49152
    v_mfma_f32_32x32x16_bf16 v[192:207], v[32:35], v[60:63], v[192:207]
    ds_read_b64_tr_b16 v[18:19], v2 offset:51200
    ds_read_b128 v[52:55], v12 offset:20480
    v_mfma_f32_32x32x16_bf16 v[144:159], v[36:39], v[56:59], v[144:159]
    ds_read_b64_tr_b16 v[20:21], v3 offset:49152
    ds_read_b64_tr_b16 v[22:23], v3 offset:51200
    v_mfma_f32_32x32x16_bf16 v[208:223], v[36:39], v[60:63], v[208:223]
    ds_read_b64_tr_b16 v[24:25], v4 offset:49152
    ds_read_b64_tr_b16 v[26:27], v4 offset:51200
    v_mfma_f32_32x32x16_bf16 v[160:175], v[40:43], v[56:59], v[160:175]
    ds_read_b64_tr_b16 v[28:29], v5 offset:49152
    ds_read_b64_tr_b16 v[30:31], v5 offset:51200
    v_mfma_f32_32x32x16_bf16 v[224:239], v[40:43], v[60:63], v[224:239]
    v_mfma_f32_32x32x16_bf16 v[176:191], v[44:47], v[56:59], v[176:191]
    v_mfma_f32_32x32x16_bf16 v[240:255], v[44:47], v[60:63], v[240:255]
    s_waitcnt lgkmcnt(7)
    v_mfma_f32_32x32x16_bf16 v[128:143], v[16:19], v[48:51], v[128:143]
    ds_read_b128 v[56:59], v13 offset:16384
    ds_read_b64_tr_b16 v[32:33], v2 offset:57344
    s_waitcnt lgkmcnt(8)
    v_mfma_f32_32x32x16_bf16 v[192:207], v[16:19], v[52:55], v[192:207]
    ds_read_b64_tr_b16 v[34:35], v2 offset:59392
    ds_read_b128 v[60:63], v13 offset:20480
    s_waitcnt lgkmcnt(8)
    v_mfma_f32_32x32x16_bf16 v[144:159], v[20:23], v[48:51], v[144:159]
    ds_read_b64_tr_b16 v[36:37], v3 offset:57344
    ds_read_b64_tr_b16 v[38:39], v3 offset:59392
    v_mfma_f32_32x32x16_bf16 v[208:223], v[20:23], v[52:55], v[208:223]
    ds_read_b64_tr_b16 v[40:41], v4 offset:57344
    ds_read_b64_tr_b16 v[42:43], v4 offset:59392
    s_waitcnt lgkmcnt(10)
    v_mfma_f32_32x32x16_bf16 v[160:175], v[24:27], v[48:51], v[160:175]
    ds_read_b64_tr_b16 v[44:45], v5 offset:57344
    ds_read_b64_tr_b16 v[46:47], v5 offset:59392
    v_mfma_f32_32x32x16_bf16 v[224:239], v[24:27], v[52:55], v[224:239]
    s_waitcnt lgkmcnt(10)
    v_mfma_f32_32x32x16_bf16 v[176:191], v[28:31], v[48:51], v[176:191]
    v_mfma_f32_32x32x16_bf16 v[240:255], v[28:31], v[52:55], v[240:255]
    s_waitcnt lgkmcnt(0)
    s_barrier
    v_mfma_f32_32x32x16_bf16 v[128:143], v[32:35], v[56:59], v[128:143]
    ds_read_b128 v[48:51], v10
    ds_read_b64_tr_b16 v[16:17], v2
    v_mfma_f32_32x32x16_bf16 v[192:207], v[32:35], v[60:63], v[192:207]
    ds_read_b64_tr_b16 v[18:19], v2 offset:2048
    ds_read_b128 v[52:55], v10 offset:4096
    v_mfma_f32_32x32x16_bf16 v[144:159], v[36:39], v[56:59], v[144:159]
    ds_read_b64_tr_b16 v[20:21], v3
    ds_read_b64_tr_b16 v[22:23], v3 offset:2048
    v_mfma_f32_32x32x16_bf16 v[208:223], v[36:39], v[60:63], v[208:223]
    ds_read_b64_tr_b16 v[24:25], v4
    ds_read_b64_tr_b16 v[26:27], v4 offset:2048
    v_mfma_f32_32x32x16_bf16 v[160:175], v[40:43], v[56:59], v[160:175]
    ds_read_b64_tr_b16 v[28:29], v5
    ds_read_b64_tr_b16 v[30:31], v5 offset:2048
    v_mfma_f32_32x32x16_bf16 v[224:239], v[40:43], v[60:63], v[224:239]
    v_mfma_f32_32x32x16_bf16 v[176:191], v[44:47], v[56:59], v[176:191]
    v_mfma_f32_32x32x16_bf16 v[240:255], v[44:47], v[60:63], v[240:255]
    s_waitcnt lgkmcnt(7)
    v_mfma_f32_32x32x16_bf16 v[128:143], v[16:19], v[48:51], v[128:143]
    ds_read_b128 v[56:59], v11
    ds_read_b64_tr_b16 v[32:33], v2 offset:8192
    s_waitcnt lgkmcnt(8)
    v_mfma_f32_32x32x16_bf16 v[192:207], v[16:19], v[52:55], v[192:207]
    ds_read_b64_tr_b16 v[34:35], v2 offset:10240
    ds_read_b128 v[60:63], v11 offset:4096
    s_waitcnt lgkmcnt(8)
    v_mfma_f32_32x32x16_bf16 v[144:159], v[20:23], v[48:51], v[144:159]
    ds_read_b64_tr_b16 v[36:37], v3 offset:8192
    ds_read_b64_tr_b16 v[38:39], v3 offset:10240
    v_mfma_f32_32x32x16_bf16 v[208:223], v[20:23], v[52:55], v[208:223]
    ds_read_b64_tr_b16 v[40:41], v4 offset:8192
    ds_read_b64_tr_b16 v[42:43], v4 offset:10240
    s_waitcnt lgkmcnt(10)
    v_mfma_f32_32x32x16_bf16 v[160:175], v[24:27], v[48:51], v[160:175]
    ds_read_b64_tr_b16 v[44:45], v5 offset:8192
    ds_read_b64_tr_b16 v[46:47], v5 offset:10240
    v_mfma_f32_32x32x16_bf16 v[224:239], v[24:27], v[52:55], v[224:239]
    s_waitcnt lgkmcnt(10)
    v_mfma_f32_32x32x16_bf16 v[176:191], v[28:31], v[48:51], v[176:191]
    v_mfma_f32_32x32x16_bf16 v[240:255], v[28:31], v[52:55], v[240:255]
    s_waitcnt lgkmcnt(0)
    s_barrier
    v_mfma_f32_32x32x16_bf16 v[128:143], v[32:35], v[56:59], v[128:143]
    ds_read_b128 v[48:51], v12
    ds_read_b64_tr_b16 v[16:17], v2 offset:16384
    v_mfma_f32_32x32x16_bf16 v[192:207], v[32:35], v[60:63], v[192:207]
    ds_read_b64_tr_b16 v[18:19], v2 offset:18432
    ds_read_b128 v[52:55], v12 offset:4096
    v_mfma_f32_32x32x16_bf16 v[144:159], v[36:39], v[56:59], v[144:159]
    ds_read_b64_tr_b16 v[20:21], v3 offset:16384
    ds_read_b64_tr_b16 v[22:23], v3 offset:18432
    v_mfma_f32_32x32x16_bf16 v[208:223], v[36:39], v[60:63], v[208:223]
    ds_read_b64_tr_b16 v[24:25], v4 offset:16384
    ds_read_b64_tr_b16 v[26:27], v4 offset:18432
    v_mfma_f32_32x32x16_bf16 v[160:175], v[40:43], v[56:59], v[160:175]
    ds_read_b64_tr_b16 v[28:29], v5 offset:16384
    ds_read_b64_tr_b16 v[30:31], v5 offset:18432
    v_mfma_f32_32x32x16_bf16 v[224:239], v[40:43], v[60:63], v[224:239]
    v_mfma_f32_32x32x16_bf16 v[176:191], v[44:47], v[56:59], v[176:191]
    v_mfma_f32_32x32x16_bf16 v[240:255], v[44:47], v[60:63], v[240:255]
    s_waitcnt lgkmcnt(7)
    v_mfma_f32_32x32x16_bf16 v[128:143], v[16:19], v[48:51], v[128:143]
    ds_read_b128 v[56:59], v13
    ds_read_b64_tr_b16 v[32:33], v2 offset:24576
    s_waitcnt lgkmcnt(8)
    v_mfma_f32_32x32x16_bf16 v[192:207], v[16:19], v[52:55], v[192:207]
    ds_read_b64_tr_b16 v[34:35], v2 offset:26624
    ds_read_b128 v[60:63], v13 offset:4096
    s_waitcnt lgkmcnt(8)
    v_mfma_f32_32x32x16_bf16 v[144:159], v[20:23], v[48:51], v[144:159]
    ds_read_b64_tr_b16 v[36:37], v3 offset:24576
    ds_read_b64_tr_b16 v[38:39], v3 offset:26624
    v_mfma_f32_32x32x16_bf16 v[208:223], v[20:23], v[52:55], v[208:223]
    ds_read_b64_tr_b16 v[40:41], v4 offset:24576
    ds_read_b64_tr_b16 v[42:43], v4 offset:26624
    s_waitcnt lgkmcnt(10)
    v_mfma_f32_32x32x16_bf16 v[160:175], v[24:27], v[48:51], v[160:175]
    ds_read_b64_tr_b16 v[44:45], v5 offset:24576
    ds_read_b64_tr_b16 v[46:47], v5 offset:26624
    v_mfma_f32_32x32x16_bf16 v[224:239], v[24:27], v[52:55], v[224:239]
    s_waitcnt lgkmcnt(10)
    v_mfma_f32_32x32x16_bf16 v[176:191], v[28:31], v[48:51], v[176:191]
    v_mfma_f32_32x32x16_bf16 v[240:255], v[28:31], v[52:55], v[240:255]
    s_waitcnt lgkmcnt(0)
    s_barrier
    v_mfma_f32_32x32x16_bf16 v[128:143], v[32:35], v[56:59], v[128:143]
    ds_read_b128 v[48:51], v10 offset:16384
    ds_read_b64_tr_b16 v[16:17], v2 offset:32768
    v_mfma_f32_32x32x16_bf16 v[192:207], v[32:35], v[60:63], v[192:207]
    ds_read_b64_tr_b16 v[18:19], v2 offset:34816
    ds_read_b128 v[52:55], v10 offset:20480
    v_mfma_f32_32x32x16_bf16 v[144:159], v[36:39], v[56:59], v[144:159]
    ds_read_b64_tr_b16 v[20:21], v3 offset:32768
    ds_read_b64_tr_b16 v[22:23], v3 offset:34816
    v_mfma_f32_32x32x16_bf16 v[208:223], v[36:39], v[60:63], v[208:223]
    ds_read_b64_tr_b16 v[24:25], v4 offset:32768
    ds_read_b64_tr_b16 v[26:27], v4 offset:34816
    v_mfma_f32_32x32x16_bf16 v[160:175], v[40:43], v[56:59], v[160:175]
    ds_read_b64_tr_b16 v[28:29], v5 offset:32768
    ds_read_b64_tr_b16 v[30:31], v5 offset:34816
    v_mfma_f32_32x32x16_bf16 v[224:239], v[40:43], v[60:63], v[224:239]
    v_mfma_f32_32x32x16_bf16 v[176:191], v[44:47], v[56:59], v[176:191]
    v_mfma_f32_32x32x16_bf16 v[240:255], v[44:47], v[60:63], v[240:255]
    s_waitcnt lgkmcnt(7)
    v_mfma_f32_32x32x16_bf16 v[128:143], v[16:19], v[48:51], v[128:143]
    ds_read_b128 v[56:59], v11 offset:16384
    ds_read_b64_tr_b16 v[32:33], v2 offset:40960
    s_waitcnt lgkmcnt(8)
    v_mfma_f32_32x32x16_bf16 v[192:207], v[16:19], v[52:55], v[192:207]
    ds_read_b64_tr_b16 v[34:35], v2 offset:43008
    ds_read_b128 v[60:63], v11 offset:20480
    s_waitcnt lgkmcnt(8)
    v_mfma_f32_32x32x16_bf16 v[144:159], v[20:23], v[48:51], v[144:159]
    ds_read_b64_tr_b16 v[36:37], v3 offset:40960
    ds_read_b64_tr_b16 v[38:39], v3 offset:43008
    v_mfma_f32_32x32x16_bf16 v[208:223], v[20:23], v[52:55], v[208:223]
    ds_read_b64_tr_b16 v[40:41], v4 offset:40960
    ds_read_b64_tr_b16 v[42:43], v4 offset:43008
    s_waitcnt lgkmcnt(10)
    v_mfma_f32_32x32x16_bf16 v[160:175], v[24:27], v[48:51], v[160:175]
    ds_read_b64_tr_b16 v[44:45], v5 offset:40960
    ds_read_b64_tr_b16 v[46:47], v5 offset:43008
    v_mfma_f32_32x32x16_bf16 v[224:239], v[24:27], v[52:55], v[224:239]
    s_waitcnt lgkmcnt(10)
    v_mfma_f32_32x32x16_bf16 v[176:191], v[28:31], v[48:51], v[176:191]
    v_mfma_f32_32x32x16_bf16 v[240:255], v[28:31], v[52:55], v[240:255]
    s_waitcnt lgkmcnt(0)
    s_barrier
    v_mfma_f32_32x32x16_bf16 v[128:143], v[32:35], v[56:59], v[128:143]
    ds_read_b128 v[48:51], v12 offset:16384
    ds_read_b64_tr_b16 v[16:17], v2 offset:49152
    v_mfma_f32_32x32x16_bf16 v[192:207], v[32:35], v[60:63], v[192:207]
    ds_read_b64_tr_b16 v[18:19], v2 offset:51200
    ds_read_b128 v[52:55], v12 offset:20480
    v_mfma_f32_32x32x16_bf16 v[144:159], v[36:39], v[56:59], v[144:159]
    ds_read_b64_tr_b16 v[20:21], v3 offset:49152
    ds_read_b64_tr_b16 v[22:23], v3 offset:51200
    v_mfma_f32_32x32x16_bf16 v[208:223], v[36:39], v[60:63], v[208:223]
    ds_read_b64_tr_b16 v[24:25], v4 offset:49152
    ds_read_b64_tr_b16 v[26:27], v4 offset:51200
    v_mfma_f32_32x32x16_bf16 v[160:175], v[40:43], v[56:59], v[160:175]
    ds_read_b64_tr_b16 v[28:29], v5 offset:49152
    ds_read_b64_tr_b16 v[30:31], v5 offset:51200
    v_mfma_f32_32x32x16_bf16 v[224:239], v[40:43], v[60:63], v[224:239]
    v_mfma_f32_32x32x16_bf16 v[176:191], v[44:47], v[56:59], v[176:191]
    v_mfma_f32_32x32x16_bf16 v[240:255], v[44:47], v[60:63], v[240:255]
    s_waitcnt lgkmcnt(7)
    v_mfma_f32_32x32x16_bf16 v[128:143], v[16:19], v[48:51], v[128:143]
    ds_read_b128 v[56:59], v13 offset:16384
    ds_read_b64_tr_b16 v[32:33], v2 offset:57344
    s_waitcnt lgkmcnt(8)
    v_mfma_f32_32x32x16_bf16 v[192:207], v[16:19], v[52:55], v[192:207]
    ds_read_b64_tr_b16 v[34:35], v2 offset:59392
    ds_read_b128 v[60:63], v13 offset:20480
    s_waitcnt lgkmcnt(8)
    v_mfma_f32_32x32x16_bf16 v[144:159], v[20:23], v[48:51], v[144:159]
    ds_read_b64_tr_b16 v[36:37], v3 offset:57344
    ds_read_b64_tr_b16 v[38:39], v3 offset:59392
    v_mfma_f32_32x32x16_bf16 v[208:223], v[20:23], v[52:55], v[208:223]
    ds_read_b64_tr_b16 v[40:41], v4 offset:57344
    ds_read_b64_tr_b16 v[42:43], v4 offset:59392
    s_waitcnt lgkmcnt(10)
    v_mfma_f32_32x32x16_bf16 v[160:175], v[24:27], v[48:51], v[160:175]
    ds_read_b64_tr_b16 v[44:45], v5 offset:57344
    ds_read_b64_tr_b16 v[46:47], v5 offset:59392
    v_mfma_f32_32x32x16_bf16 v[224:239], v[24:27], v[52:55], v[224:239]
    s_waitcnt lgkmcnt(10)
    v_mfma_f32_32x32x16_bf16 v[176:191], v[28:31], v[48:51], v[176:191]
    v_mfma_f32_32x32x16_bf16 v[240:255], v[28:31], v[52:55], v[240:255]
    s_waitcnt lgkmcnt(0)
    s_barrier
    v_mfma_f32_32x32x16_bf16 v[128:143], v[32:35], v[56:59], v[128:143]
    ds_read_b128 v[48:51], v10
    ds_read_b64_tr_b16 v[16:17], v2
    v_mfma_f32_32x32x16_bf16 v[192:207], v[32:35], v[60:63], v[192:207]
    ds_read_b64_tr_b16 v[18:19], v2 offset:2048
    ds_read_b128 v[52:55], v10 offset:4096
    v_mfma_f32_32x32x16_bf16 v[144:159], v[36:39], v[56:59], v[144:159]
    ds_read_b64_tr_b16 v[20:21], v3
    ds_read_b64_tr_b16 v[22:23], v3 offset:2048
    v_mfma_f32_32x32x16_bf16 v[208:223], v[36:39], v[60:63], v[208:223]
    ds_read_b64_tr_b16 v[24:25], v4
    ds_read_b64_tr_b16 v[26:27], v4 offset:2048
    v_mfma_f32_32x32x16_bf16 v[160:175], v[40:43], v[56:59], v[160:175]
    ds_read_b64_tr_b16 v[28:29], v5
    ds_read_b64_tr_b16 v[30:31], v5 offset:2048
    v_mfma_f32_32x32x16_bf16 v[224:239], v[40:43], v[60:63], v[224:239]
    v_mfma_f32_32x32x16_bf16 v[176:191], v[44:47], v[56:59], v[176:191]
    v_mfma_f32_32x32x16_bf16 v[240:255], v[44:47], v[60:63], v[240:255]
    s_waitcnt lgkmcnt(7)
    v_mfma_f32_32x32x16_bf16 v[128:143], v[16:19], v[48:51], v[128:143]
    ds_read_b128 v[56:59], v11
    ds_read_b64_tr_b16 v[32:33], v2 offset:8192
    s_waitcnt lgkmcnt(8)
    v_mfma_f32_32x32x16_bf16 v[192:207], v[16:19], v[52:55], v[192:207]
    ds_read_b64_tr_b16 v[34:35], v2 offset:10240
    ds_read_b128 v[60:63], v11 offset:4096
    s_waitcnt lgkmcnt(8)
    v_mfma_f32_32x32x16_bf16 v[144:159], v[20:23], v[48:51], v[144:159]
    ds_read_b64_tr_b16 v[36:37], v3 offset:8192
    ds_read_b64_tr_b16 v[38:39], v3 offset:10240
    v_mfma_f32_32x32x16_bf16 v[208:223], v[20:23], v[52:55], v[208:223]
    ds_read_b64_tr_b16 v[40:41], v4 offset:8192
    ds_read_b64_tr_b16 v[42:43], v4 offset:10240
    s_waitcnt lgkmcnt(10)
    v_mfma_f32_32x32x16_bf16 v[160:175], v[24:27], v[48:51], v[160:175]
    ds_read_b64_tr_b16 v[44:45], v5 offset:8192
    ds_read_b64_tr_b16 v[46:47], v5 offset:10240
    v_mfma_f32_32x32x16_bf16 v[224:239], v[24:27], v[52:55], v[224:239]
    s_waitcnt lgkmcnt(10)
    v_mfma_f32_32x32x16_bf16 v[176:191], v[28:31], v[48:51], v[176:191]
    v_mfma_f32_32x32x16_bf16 v[240:255], v[28:31], v[52:55], v[240:255]
    s_waitcnt lgkmcnt(0)
    s_barrier
    v_mfma_f32_32x32x16_bf16 v[128:143], v[32:35], v[56:59], v[128:143]
    ds_read_b128 v[48:51], v12
    ds_read_b64_tr_b16 v[16:17], v2 offset:16384
    v_mfma_f32_32x32x16_bf16 v[192:207], v[32:35], v[60:63], v[192:207]
    ds_read_b64_tr_b16 v[18:19], v2 offset:18432
    ds_read_b128 v[52:55], v12 offset:4096
    v_mfma_f32_32x32x16_bf16 v[144:159], v[36:39], v[56:59], v[144:159]
    ds_read_b64_tr_b16 v[20:21], v3 offset:16384
    ds_read_b64_tr_b16 v[22:23], v3 offset:18432
    v_mfma_f32_32x32x16_bf16 v[208:223], v[36:39], v[60:63], v[208:223]
    ds_read_b64_tr_b16 v[24:25], v4 offset:16384
    ds_read_b64_tr_b16 v[26:27], v4 offset:18432
    v_mfma_f32_32x32x16_bf16 v[160:175], v[40:43], v[56:59], v[160:175]
    ds_read_b64_tr_b16 v[28:29], v5 offset:16384
    ds_read_b64_tr_b16 v[30:31], v5 offset:18432
    v_mfma_f32_32x32x16_bf16 v[224:239], v[40:43], v[60:63], v[224:239]
    v_mfma_f32_32x32x16_bf16 v[176:191], v[44:47], v[56:59], v[176:191]
    v_mfma_f32_32x32x16_bf16 v[240:255], v[44:47], v[60:63], v[240:255]
    s_waitcnt lgkmcnt(7)
    v_mfma_f32_32x32x16_bf16 v[128:143], v[16:19], v[48:51], v[128:143]
    ds_read_b128 v[56:59], v13
    ds_read_b64_tr_b16 v[32:33], v2 offset:24576
    s_waitcnt lgkmcnt(8)
    v_mfma_f32_32x32x16_bf16 v[192:207], v[16:19], v[52:55], v[192:207]
    ds_read_b64_tr_b16 v[34:35], v2 offset:26624
    ds_read_b128 v[60:63], v13 offset:4096
    s_waitcnt lgkmcnt(8)
    v_mfma_f32_32x32x16_bf16 v[144:159], v[20:23], v[48:51], v[144:159]
    ds_read_b64_tr_b16 v[36:37], v3 offset:24576
    ds_read_b64_tr_b16 v[38:39], v3 offset:26624
    v_mfma_f32_32x32x16_bf16 v[208:223], v[20:23], v[52:55], v[208:223]
    ds_read_b64_tr_b16 v[40:41], v4 offset:24576
    ds_read_b64_tr_b16 v[42:43], v4 offset:26624
    s_waitcnt lgkmcnt(10)
    v_mfma_f32_32x32x16_bf16 v[160:175], v[24:27], v[48:51], v[160:175]
    ds_read_b64_tr_b16 v[44:45], v5 offset:24576
    ds_read_b64_tr_b16 v[46:47], v5 offset:26624
    v_mfma_f32_32x32x16_bf16 v[224:239], v[24:27], v[52:55], v[224:239]
    s_waitcnt lgkmcnt(10)
    v_mfma_f32_32x32x16_bf16 v[176:191], v[28:31], v[48:51], v[176:191]
    v_mfma_f32_32x32x16_bf16 v[240:255], v[28:31], v[52:55], v[240:255]
    s_waitcnt lgkmcnt(0)
    s_barrier
    v_mfma_f32_32x32x16_bf16 v[128:143], v[32:35], v[56:59], v[128:143]
    ds_read_b128 v[48:51], v10 offset:16384
    ds_read_b64_tr_b16 v[16:17], v2 offset:32768
    v_mfma_f32_32x32x16_bf16 v[192:207], v[32:35], v[60:63], v[192:207]
    ds_read_b64_tr_b16 v[18:19], v2 offset:34816
    ds_read_b128 v[52:55], v10 offset:20480
    v_mfma_f32_32x32x16_bf16 v[144:159], v[36:39], v[56:59], v[144:159]
    ds_read_b64_tr_b16 v[20:21], v3 offset:32768
    ds_read_b64_tr_b16 v[22:23], v3 offset:34816
    v_mfma_f32_32x32x16_bf16 v[208:223], v[36:39], v[60:63], v[208:223]
    ds_read_b64_tr_b16 v[24:25], v4 offset:32768
    ds_read_b64_tr_b16 v[26:27], v4 offset:34816
    v_mfma_f32_32x32x16_bf16 v[160:175], v[40:43], v[56:59], v[160:175]
    ds_read_b64_tr_b16 v[28:29], v5 offset:32768
    ds_read_b64_tr_b16 v[30:31], v5 offset:34816
    v_mfma_f32_32x32x16_bf16 v[224:239], v[40:43], v[60:63], v[224:239]
    v_mfma_f32_32x32x16_bf16 v[176:191], v[44:47], v[56:59], v[176:191]
    v_mfma_f32_32x32x16_bf16 v[240:255], v[44:47], v[60:63], v[240:255]
    s_waitcnt lgkmcnt(7)
    v_mfma_f32_32x32x16_bf16 v[128:143], v[16:19], v[48:51], v[128:143]
    ds_read_b128 v[56:59], v11 offset:16384
    ds_read_b64_tr_b16 v[32:33], v2 offset:40960
    s_waitcnt lgkmcnt(8)
    v_mfma_f32_32x32x16_bf16 v[192:207], v[16:19], v[52:55], v[192:207]
    ds_read_b64_tr_b16 v[34:35], v2 offset:43008
    ds_read_b128 v[60:63], v11 offset:20480
    s_waitcnt lgkmcnt(8)
    v_mfma_f32_32x32x16_bf16 v[144:159], v[20:23], v[48:51], v[144:159]
    ds_read_b64_tr_b16 v[36:37], v3 offset:40960
    ds_read_b64_tr_b16 v[38:39], v3 offset:43008
    v_mfma_f32_32x32x16_bf16 v[208:223], v[20:23], v[52:55], v[208:223]
    ds_read_b64_tr_b16 v[40:41], v4 offset:40960
    ds_read_b64_tr_b16 v[42:43], v4 offset:43008
    s_waitcnt lgkmcnt(10)
    v_mfma_f32_32x32x16_bf16 v[160:175], v[24:27], v[48:51], v[160:175]
    ds_read_b64_tr_b16 v[44:45], v5 offset:40960
    ds_read_b64_tr_b16 v[46:47], v5 offset:43008
    v_mfma_f32_32x32x16_bf16 v[224:239], v[24:27], v[52:55], v[224:239]
    s_waitcnt lgkmcnt(10)
    v_mfma_f32_32x32x16_bf16 v[176:191], v[28:31], v[48:51], v[176:191]
    v_mfma_f32_32x32x16_bf16 v[240:255], v[28:31], v[52:55], v[240:255]
    s_waitcnt lgkmcnt(0)
    s_barrier
    v_mfma_f32_32x32x16_bf16 v[128:143], v[32:35], v[56:59], v[128:143]
    ds_read_b128 v[48:51], v12 offset:16384
    ds_read_b64_tr_b16 v[16:17], v2 offset:49152
    v_mfma_f32_32x32x16_bf16 v[192:207], v[32:35], v[60:63], v[192:207]
    ds_read_b64_tr_b16 v[18:19], v2 offset:51200
    ds_read_b128 v[52:55], v12 offset:20480
    v_mfma_f32_32x32x16_bf16 v[144:159], v[36:39], v[56:59], v[144:159]
    ds_read_b64_tr_b16 v[20:21], v3 offset:49152
    ds_read_b64_tr_b16 v[22:23], v3 offset:51200
    v_mfma_f32_32x32x16_bf16 v[208:223], v[36:39], v[60:63], v[208:223]
    ds_read_b64_tr_b16 v[24:25], v4 offset:49152
    ds_read_b64_tr_b16 v[26:27], v4 offset:51200
    v_mfma_f32_32x32x16_bf16 v[160:175], v[40:43], v[56:59], v[160:175]
    ds_read_b64_tr_b16 v[28:29], v5 offset:49152
    ds_read_b64_tr_b16 v[30:31], v5 offset:51200
    v_mfma_f32_32x32x16_bf16 v[224:239], v[40:43], v[60:63], v[224:239]
    v_mfma_f32_32x32x16_bf16 v[176:191], v[44:47], v[56:59], v[176:191]
    v_mfma_f32_32x32x16_bf16 v[240:255], v[44:47], v[60:63], v[240:255]
    s_waitcnt lgkmcnt(7)
    v_mfma_f32_32x32x16_bf16 v[128:143], v[16:19], v[48:51], v[128:143]
    ds_read_b128 v[56:59], v13 offset:16384
    ds_read_b64_tr_b16 v[32:33], v2 offset:57344
    s_waitcnt lgkmcnt(8)
    v_mfma_f32_32x32x16_bf16 v[192:207], v[16:19], v[52:55], v[192:207]
    ds_read_b64_tr_b16 v[34:35], v2 offset:59392
    ds_read_b128 v[60:63], v13 offset:20480
    s_waitcnt lgkmcnt(8)
    v_mfma_f32_32x32x16_bf16 v[144:159], v[20:23], v[48:51], v[144:159]
    ds_read_b64_tr_b16 v[36:37], v3 offset:57344
    ds_read_b64_tr_b16 v[38:39], v3 offset:59392
    v_mfma_f32_32x32x16_bf16 v[208:223], v[20:23], v[52:55], v[208:223]
    ds_read_b64_tr_b16 v[40:41], v4 offset:57344
    ds_read_b64_tr_b16 v[42:43], v4 offset:59392
    s_waitcnt lgkmcnt(10)
    v_mfma_f32_32x32x16_bf16 v[160:175], v[24:27], v[48:51], v[160:175]
    ds_read_b64_tr_b16 v[44:45], v5 offset:57344
    ds_read_b64_tr_b16 v[46:47], v5 offset:59392
    v_mfma_f32_32x32x16_bf16 v[224:239], v[24:27], v[52:55], v[224:239]
    s_waitcnt lgkmcnt(10)
    v_mfma_f32_32x32x16_bf16 v[176:191], v[28:31], v[48:51], v[176:191]
    v_mfma_f32_32x32x16_bf16 v[240:255], v[28:31], v[52:55], v[240:255]
    s_waitcnt lgkmcnt(0)
    s_barrier
    v_mfma_f32_32x32x16_bf16 v[128:143], v[32:35], v[56:59], v[128:143]
    v_and_b32 v0, 15, v1
    s_waitcnt vmcnt(0)
    v_lshrrev_b32 v14, 5, v1
    v_xor_b32 v0, v0, v14
    v_lshlrev_b32 v0, 4, v0
    v_and_b32 v2, 31, v1
    v_lshlrev_b32 v2, 8, v2
    v_add_u32 v2, s74, v2
    v_or_b32 v2, v2, v0
    v_mfma_f32_32x32x16_bf16 v[144:159], v[36:39], v[56:59], v[144:159]
    v_xor_b32 v3, 32, v2
    v_xor_b32 v4, 64, v2
    v_xor_b32 v5, 96, v2
    v_xor_b32 v6, 128, v2
    v_xor_b32 v7, 160, v2
    v_xor_b32 v8, 192, v2
    v_xor_b32 v9, 224, v2
    ds_read_b128 v[96:99], v2
    v_mfma_f32_32x32x16_bf16 v[160:175], v[40:43], v[56:59], v[160:175]
    ds_read_b128 v[100:103], v3
    ds_read_b128 v[104:107], v4
    ds_read_b128 v[108:111], v5
    ds_read_b128 v[112:115], v6
    v_mfma_f32_32x32x16_bf16 v[176:191], v[44:47], v[56:59], v[176:191]
    ds_read_b128 v[116:119], v7
    ds_read_b128 v[120:123], v8
    ds_read_b128 v[124:127], v9
    v_bfe_u32 v0, v1, 2, 2
    v_mfma_f32_32x32x16_bf16 v[192:207], v[32:35], v[60:63], v[192:207]
    v_lshrrev_b32 v14, 5, v1
    v_lshlrev_b32 v14, 2, v14
    v_add_u32 v14, v14, v0
    v_lshlrev_b32 v14, 8, v14
    v_add_u32 v14, s75, v14
    v_bfe_u32 v10, v1, 4, 1
    v_mfma_f32_32x32x16_bf16 v[208:223], v[36:39], v[60:63], v[208:223]
    v_lshlrev_b32 v10, 5, v10
    v_add_u32 v14, v14, v10
    v_and_b32 v10, 3, v1
    v_lshlrev_b32 v10, 3, v10
    v_add_u32 v14, v14, v10
    v_lshlrev_b32 v0, 6, v0
    v_mfma_f32_32x32x16_bf16 v[224:239], v[40:43], v[60:63], v[224:239]
    v_xor_b32 v10, 0, v0
    v_add_u32 v10, v10, v14
    v_xor_b32 v11, 64, v0
    v_add_u32 v11, v11, v14
    v_xor_b32 v12, 128, v0
    v_add_u32 v12, v12, v14
    v_mfma_f32_32x32x16_bf16 v[240:255], v[44:47], v[60:63], v[240:255]
    v_xor_b32 v13, 192, v0
    v_add_u32 v13, v13, v14
    v_cvt_pk_bf16_f32 v64, v128, v129
    v_cvt_pk_bf16_f32 v65, v130, v131
    v_cvt_pk_bf16_f32 v66, v132, v133
    v_cvt_pk_bf16_f32 v67, v134, v135
    v_cvt_pk_bf16_f32 v68, v136, v137
    v_cvt_pk_bf16_f32 v69, v138, v139
    v_cvt_pk_bf16_f32 v70, v140, v141
    v_cvt_pk_bf16_f32 v71, v142, v143
    s_waitcnt lgkmcnt(7)
    v_mfma_f32_32x32x16_bf16 v[128:143], v[96:99], v[64:67], 0
    v_cvt_pk_bf16_f32 v72, v144, v145
    v_cvt_pk_bf16_f32 v73, v146, v147
    v_cvt_pk_bf16_f32 v74, v148, v149
    v_cvt_pk_bf16_f32 v75, v150, v151
    v_cvt_pk_bf16_f32 v76, v152, v153
    v_cvt_pk_bf16_f32 v77, v154, v155
    v_cvt_pk_bf16_f32 v78, v156, v157
    v_cvt_pk_bf16_f32 v79, v158, v159
    s_waitcnt lgkmcnt(6)
    v_mfma_f32_32x32x16_bf16 v[128:143], v[100:103], v[68:71], v[128:143]
    v_cvt_pk_bf16_f32 v80, v160, v161
    s_waitcnt lgkmcnt(5)
    v_mfma_f32_32x32x16_bf16 v[128:143], v[104:107], v[72:75], v[128:143]
    v_cvt_pk_bf16_f32 v81, v162, v163
    v_cvt_pk_bf16_f32 v82, v164, v165
    v_cvt_pk_bf16_f32 v83, v166, v167
    v_cvt_pk_bf16_f32 v84, v168, v169
    v_cvt_pk_bf16_f32 v85, v170, v171
    v_cvt_pk_bf16_f32 v86, v172, v173
    v_cvt_pk_bf16_f32 v87, v174, v175
    v_cvt_pk_bf16_f32 v88, v176, v177
    s_waitcnt lgkmcnt(4)
    v_mfma_f32_32x32x16_bf16 v[128:143], v[108:111], v[76:79], v[128:143]
    v_cvt_pk_bf16_f32 v89, v178, v179
    s_waitcnt lgkmcnt(3)
    v_mfma_f32_32x32x16_bf16 v[128:143], v[112:115], v[80:83], v[128:143]
    v_cvt_pk_bf16_f32 v90, v180, v181
    v_cvt_pk_bf16_f32 v91, v182, v183
    v_cvt_pk_bf16_f32 v92, v184, v185
    v_cvt_pk_bf16_f32 v93, v186, v187
    v_cvt_pk_bf16_f32 v94, v188, v189
    v_cvt_pk_bf16_f32 v95, v190, v191
    ds_read_b128 v[144:147], v2 offset:8192
    ds_read_b128 v[148:151], v3 offset:8192
    s_waitcnt lgkmcnt(4)
    v_mfma_f32_32x32x16_bf16 v[128:143], v[116:119], v[84:87], v[128:143]
    ds_read_b128 v[152:155], v4 offset:8192
    ds_read_b128 v[156:159], v5 offset:8192
    ds_read_b128 v[160:163], v6 offset:8192
    ds_read_b128 v[164:167], v7 offset:8192
    ds_read_b128 v[168:171], v8 offset:8192
    ds_read_b128 v[172:175], v9 offset:8192
    s_waitcnt lgkmcnt(9)
    v_mfma_f32_32x32x16_bf16 v[128:143], v[120:123], v[88:91], v[128:143]
    v_cvt_pk_bf16_f32 v16, v192, v193
    v_cvt_pk_bf16_f32 v17, v194, v195
    v_cvt_pk_bf16_f32 v18, v196, v197
    v_cvt_pk_bf16_f32 v19, v198, v199
    v_cvt_pk_bf16_f32 v20, v200, v201
    v_cvt_pk_bf16_f32 v21, v202, v203
    s_waitcnt lgkmcnt(8)
    v_mfma_f32_32x32x16_bf16 v[128:143], v[124:127], v[92:95], v[128:143]
    v_cvt_pk_bf16_f32 v22, v204, v205
    v_cvt_pk_bf16_f32 v23, v206, v207
    v_cvt_pk_bf16_f32 v24, v208, v209
    v_cvt_pk_bf16_f32 v25, v210, v211
    v_cvt_pk_bf16_f32 v26, v212, v213
    v_cvt_pk_bf16_f32 v27, v214, v215
    v_cvt_pk_bf16_f32 v28, v216, v217
    v_cvt_pk_bf16_f32 v29, v218, v219
    v_cvt_pk_bf16_f32 v30, v220, v221
    v_cvt_pk_bf16_f32 v31, v222, v223
    v_cvt_pk_bf16_f32 v32, v224, v225
    v_cvt_pk_bf16_f32 v33, v226, v227
    v_cvt_pk_bf16_f32 v34, v228, v229
    v_cvt_pk_bf16_f32 v35, v230, v231
    v_cvt_pk_bf16_f32 v36, v232, v233
    v_cvt_pk_bf16_f32 v37, v234, v235
    v_cvt_pk_bf16_f32 v38, v236, v237
    v_cvt_pk_bf16_f32 v39, v238, v239
    v_cvt_pk_bf16_f32 v40, v240, v241
    v_cvt_pk_bf16_f32 v41, v242, v243
    v_cvt_pk_bf16_f32 v42, v244, v245
    v_cvt_pk_bf16_f32 v43, v246, v247
    v_cvt_pk_bf16_f32 v44, v248, v249
    v_cvt_pk_bf16_f32 v45, v250, v251
    v_cvt_pk_bf16_f32 v46, v252, v253
    v_cvt_pk_bf16_f32 v47, v254, v255
    s_waitcnt lgkmcnt(0)
    s_barrier
    v_lshlrev_b32 v0, 4, v1
    s_lshr_b32 s44, s43, 1
    s_lshl_b32 s44, s44, 15
    s_and_b32 s45, s43, 1
    s_lshl_b32 s45, s45, 13
    s_add_u32 s44, s44, s45
    v_add_u32 v0, s44, v0
    v_mfma_f32_32x32x16_bf16 v[176:191], v[144:147], v[16:19], 0
    ds_read_b64_tr_b16 v[96:97], v10
    ds_read_b64_tr_b16 v[98:99], v10 offset:2048
    ds_read_b64_tr_b16 v[104:105], v11
    ds_read_b64_tr_b16 v[106:107], v11 offset:2048
    v_mfma_f32_32x32x16_bf16 v[176:191], v[148:151], v[20:23], v[176:191]
    ds_read_b64_tr_b16 v[112:113], v12
    ds_read_b64_tr_b16 v[114:115], v12 offset:2048
    ds_read_b64_tr_b16 v[120:121], v13
    ds_read_b64_tr_b16 v[122:123], v13 offset:2048
    v_mfma_f32_32x32x16_bf16 v[176:191], v[152:155], v[24:27], v[176:191]
    ds_read_b64_tr_b16 v[100:101], v10 offset:4096
    ds_read_b64_tr_b16 v[102:103], v10 offset:6144
    ds_read_b64_tr_b16 v[108:109], v11 offset:4096
    ds_read_b64_tr_b16 v[110:111], v11 offset:6144
    v_mfma_f32_32x32x16_bf16 v[176:191], v[156:159], v[28:31], v[176:191]
    ds_read_b64_tr_b16 v[116:117], v12 offset:4096
    ds_read_b64_tr_b16 v[118:119], v12 offset:6144
    ds_read_b64_tr_b16 v[124:125], v13 offset:4096
    ds_read_b64_tr_b16 v[126:127], v13 offset:6144
    v_max3_f32 v2, v128, v129, v130
    v_max3_f32 v3, v131, v132, v133
    v_mfma_f32_32x32x16_bf16 v[176:191], v[160:163], v[32:35], v[176:191]
    v_max3_f32 v2, v2, v134, v135
    v_max3_f32 v3, v3, v136, v137
    v_max3_f32 v2, v2, v138, v139
    v_max3_f32 v3, v3, v140, v141
    v_max3_f32 v2, v2, v142, v143
    v_max_f32 v2, v2, v3
    v_mov_b32 v3, v2
    s_nop 1
    v_permlane32_swap_b32 v3, v2
    v_mfma_f32_32x32x16_bf16 v[176:191], v[164:167], v[36:39], v[176:191]
    v_max_f32 v2, v2, v3
    v_mul_f32 v2, s76, v2
    v_fma_f32 v128, v128, s76, -v2
    v_fma_f32 v129, v129, s76, -v2
    v_fma_f32 v130, v130, s76, -v2
    v_fma_f32 v131, v131, s76, -v2
    v_fma_f32 v132, v132, s76, -v2
    v_fma_f32 v133, v133, s76, -v2
    v_mfma_f32_32x32x16_bf16 v[176:191], v[168:171], v[40:43], v[176:191]
    v_fma_f32 v134, v134, s76, -v2
    v_fma_f32 v135, v135, s76, -v2
    v_fma_f32 v136, v136, s76, -v2
    v_fma_f32 v137, v137, s76, -v2
    v_fma_f32 v138, v138, s76, -v2
    v_fma_f32 v139, v139, s76, -v2
    v_fma_f32 v140, v140, s76, -v2
    v_fma_f32 v141, v141, s76, -v2
    v_mfma_f32_32x32x16_bf16 v[176:191], v[172:175], v[44:47], v[176:191]
    v_fma_f32 v142, v142, s76, -v2
    v_fma_f32 v143, v143, s76, -v2
    v_exp_f32 v128, v128
    v_exp_f32 v129, v129
    v_exp_f32 v130, v130
    v_exp_f32 v131, v131
    v_exp_f32 v132, v132
    v_exp_f32 v133, v133
    s_nop 3
    ds_write_b128 v0, v[176:179] offset:4096
    ds_write_b128 v0, v[180:183] offset:5120
    ds_write_b128 v0, v[184:187] offset:6144
    ds_write_b128 v0, v[188:191] offset:7168
    v_exp_f32 v134, v134
    v_exp_f32 v135, v135
    v_exp_f32 v136, v136
    v_exp_f32 v137, v137
    v_exp_f32 v138, v138
    v_exp_f32 v139, v139
    v_exp_f32 v140, v140
    v_exp_f32 v141, v141
    v_exp_f32 v142, v142
    v_exp_f32 v143, v143
    v_add_f32 v4, v128, v129
    v_add_f32 v5, v130, v131
    v_add_f32 v4, v4, v132
    v_add_f32 v5, v5, v133
    v_add_f32 v4, v4, v134
    v_add_f32 v5, v5, v135
    s_waitcnt lgkmcnt(0)
    s_barrier
    v_add_f32 v4, v4, v136
    v_add_f32 v5, v5, v137
    v_add_f32 v4, v4, v138
    v_add_f32 v5, v5, v139
    v_add_f32 v4, v4, v140
    v_add_f32 v5, v5, v141
    v_add_f32 v4, v4, v142
    v_add_f32 v5, v5, v143
    v_add_f32 v4, v4, v5
    v_mov_b32 v5, v4
    s_nop 1
    v_permlane32_swap_b32 v5, v4
    v_add_f32 v4, v4, v5
    v_rcp_f32 v4, v4
    s_nop 0
    v_mul_f32 v128, v128, v4
    v_mul_f32 v129, v129, v4
    v_mul_f32 v130, v130, v4
    v_mul_f32 v131, v131, v4
    v_mul_f32 v132, v132, v4
    v_mul_f32 v133, v133, v4
    v_mul_f32 v134, v134, v4
    v_mul_f32 v135, v135, v4
    v_mul_f32 v136, v136, v4
    v_mul_f32 v137, v137, v4
    v_mul_f32 v138, v138, v4
    v_mul_f32 v139, v139, v4
    v_mul_f32 v140, v140, v4
    v_mul_f32 v141, v141, v4
    v_mul_f32 v142, v142, v4
    v_mul_f32 v143, v143, v4
    v_cvt_pk_bf16_f32 v48, v128, v129
    v_cvt_pk_bf16_f32 v49, v130, v131
    v_cvt_pk_bf16_f32 v50, v132, v133
    v_cvt_pk_bf16_f32 v51, v134, v135
    v_cvt_pk_bf16_f32 v52, v136, v137
    v_cvt_pk_bf16_f32 v53, v138, v139
    v_cvt_pk_bf16_f32 v54, v140, v141
    v_cvt_pk_bf16_f32 v55, v142, v143
    v_mfma_f32_32x32x16_bf16 v[192:207], v[96:99], v[48:51], 0
    v_mfma_f32_32x32x16_bf16 v[208:223], v[104:107], v[48:51], 0
    v_mfma_f32_32x32x16_bf16 v[192:207], v[100:103], v[52:55], v[192:207]
    v_mfma_f32_32x32x16_bf16 v[208:223], v[108:111], v[52:55], v[208:223]
    v_mfma_f32_32x32x16_bf16 v[224:239], v[112:115], v[48:51], 0
    v_mfma_f32_32x32x16_bf16 v[240:255], v[120:123], v[48:51], 0
    s_nop 8
    v_cvt_pk_bf16_f32 v64, v192, v193
    v_cvt_pk_bf16_f32 v65, v194, v195
    v_cvt_pk_bf16_f32 v66, v196, v197
    v_mfma_f32_32x32x16_bf16 v[224:239], v[116:119], v[52:55], v[224:239]
    v_cvt_pk_bf16_f32 v67, v198, v199
    ds_write_b128 v0, v[64:67]
    v_cvt_pk_bf16_f32 v68, v200, v201
    v_mfma_f32_32x32x16_bf16 v[240:255], v[124:127], v[52:55], v[240:255]
    v_cvt_pk_bf16_f32 v69, v202, v203
    v_cvt_pk_bf16_f32 v70, v204, v205
    v_cvt_pk_bf16_f32 v71, v206, v207
    ds_write_b128 v0, v[68:71] offset:1024
    v_cvt_pk_bf16_f32 v72, v208, v209
    v_cvt_pk_bf16_f32 v73, v210, v211
    v_cvt_pk_bf16_f32 v74, v212, v213
    v_cvt_pk_bf16_f32 v75, v214, v215
    ds_write_b128 v0, v[72:75] offset:2048
    v_cvt_pk_bf16_f32 v76, v216, v217
    v_cvt_pk_bf16_f32 v77, v218, v219
    v_cvt_pk_bf16_f32 v78, v220, v221
    v_cvt_pk_bf16_f32 v79, v222, v223
    ds_write_b128 v0, v[76:79] offset:3072
    v_cvt_pk_bf16_f32 v80, v224, v225
    v_cvt_pk_bf16_f32 v81, v226, v227
    v_cvt_pk_bf16_f32 v82, v228, v229
    v_cvt_pk_bf16_f32 v83, v230, v231
    ds_write_b128 v0, v[80:83] offset:16384
    v_cvt_pk_bf16_f32 v84, v232, v233
    v_cvt_pk_bf16_f32 v85, v234, v235
    v_cvt_pk_bf16_f32 v86, v236, v237
    v_cvt_pk_bf16_f32 v87, v238, v239
    ds_write_b128 v0, v[84:87] offset:17408
    v_cvt_pk_bf16_f32 v88, v240, v241
    v_cvt_pk_bf16_f32 v89, v242, v243
    v_cvt_pk_bf16_f32 v90, v244, v245
    v_cvt_pk_bf16_f32 v91, v246, v247
    ds_write_b128 v0, v[88:91] offset:18432
    v_cvt_pk_bf16_f32 v92, v248, v249
    v_cvt_pk_bf16_f32 v93, v250, v251
    v_cvt_pk_bf16_f32 v94, v252, v253
    v_cvt_pk_bf16_f32 v95, v254, v255
    ds_write_b128 v0, v[92:95] offset:19456
    v_lshrrev_b32 v16, 5, v1
    v_bfe_u32 v17, v1, 4, 1
    v_bfe_u32 v18, v1, 2, 2
    v_and_b32 v19, 3, v1
    v_and_b32 v20, 1, v19
    v_lshlrev_b32 v20, 4, v20
    v_lshrrev_b32 v21, 1, v19
    v_lshlrev_b32 v21, 3, v21
    v_or_b32 v20, v20, v21
    v_lshlrev_b32 v21, 5, v17
    v_or_b32 v20, v20, v21
    v_lshlrev_b32 v21, 2, v16
    v_add_u32 v21, v21, v18
    v_lshlrev_b32 v21, 8, v21
    v_add_u32 v20, v20, v21
    s_lshr_b32 s44, s43, 1
    s_lshl_b32 s44, s44, 1
    s_add_u32 s45, s44, 0
    v_xor_b32 v21, s45, v18
    v_lshlrev_b32 v21, 6, v21
    v_add_u32 v2, v20, v21
    v_add_u32 v2, 65536, v2
    v_add_u32 v4, 65536, v2
    s_add_u32 s45, s44, 1
    v_xor_b32 v21, s45, v18
    v_lshlrev_b32 v21, 6, v21
    v_add_u32 v3, v20, v21
    v_add_u32 v3, 65536, v3
    v_add_u32 v5, 65536, v3
    v_lshlrev_b32 v20, 4, v1
    s_and_b32 s44, s43, 1
    s_lshl_b32 s44, s44, 13
    v_add_u32 v6, s44, v20
    s_waitcnt lgkmcnt(0)
    s_barrier
    ds_read_b128 v[32:35], v6
    ds_read_b64_tr_b16 v[16:17], v2 offset:49152
    ds_read_b64_tr_b16 v[18:19], v2 offset:51200
    ds_read_b128 v[36:39], v6 offset:4096
    ds_read_b64_tr_b16 v[20:21], v3 offset:49152
    ds_read_b64_tr_b16 v[22:23], v3 offset:51200
    s_waitcnt lgkmcnt(3)
    v_mfma_f32_32x32x16_bf16 v[64:79], v[16:19], v[32:35], 0
    ds_read_b128 v[40:43], v6 offset:1024
    ds_read_b64_tr_b16 v[24:25], v2 offset:53248
    s_waitcnt lgkmcnt(4)
    v_mfma_f32_32x32x16_bf16 v[80:95], v[16:19], v[36:39], 0
    ds_read_b64_tr_b16 v[26:27], v2 offset:55296
    ds_read_b128 v[44:47], v6 offset:5120
    s_waitcnt lgkmcnt(4)
    v_mfma_f32_32x32x16_bf16 v[96:111], v[20:23], v[32:35], 0
    ds_read_b64_tr_b16 v[28:29], v3 offset:53248
    ds_read_b64_tr_b16 v[30:31], v3 offset:55296
    v_mfma_f32_32x32x16_bf16 v[112:127], v[20:23], v[36:39], 0
    s_waitcnt lgkmcnt(3)
    v_mfma_f32_32x32x16_bf16 v[64:79], v[24:27], v[40:43], v[64:79]
    ds_read_b128 v[32:35], v6 offset:2048
    ds_read_b64_tr_b16 v[16:17], v2 offset:57344
    s_waitcnt lgkmcnt(4)
    v_mfma_f32_32x32x16_bf16 v[80:95], v[24:27], v[44:47], v[80:95]
    ds_read_b64_tr_b16 v[18:19], v2 offset:59392
    ds_read_b128 v[36:39], v6 offset:6144
    s_waitcnt lgkmcnt(4)
    v_mfma_f32_32x32x16_bf16 v[96:111], v[28:31], v[40:43], v[96:111]
    ds_read_b64_tr_b16 v[20:21], v3 offset:57344
    ds_read_b64_tr_b16 v[22:23], v3 offset:59392
    v_mfma_f32_32x32x16_bf16 v[112:127], v[28:31], v[44:47], v[112:127]
    s_waitcnt lgkmcnt(3)
    v_mfma_f32_32x32x16_bf16 v[64:79], v[16:19], v[32:35], v[64:79]
    ds_read_b128 v[40:43], v6 offset:3072
    ds_read_b64_tr_b16 v[24:25], v2 offset:61440
    s_waitcnt lgkmcnt(4)
    v_mfma_f32_32x32x16_bf16 v[80:95], v[16:19], v[36:39], v[80:95]
    ds_read_b64_tr_b16 v[26:27], v2 offset:63488
    ds_read_b128 v[44:47], v6 offset:7168
    s_waitcnt lgkmcnt(4)
    v_mfma_f32_32x32x16_bf16 v[96:111], v[20:23], v[32:35], v[96:111]
    ds_read_b64_tr_b16 v[28:29], v3 offset:61440
    ds_read_b64_tr_b16 v[30:31], v3 offset:63488
    v_mfma_f32_32x32x16_bf16 v[112:127], v[20:23], v[36:39], v[112:127]
    s_waitcnt lgkmcnt(0)
    s_barrier
    v_mfma_f32_32x32x16_bf16 v[64:79], v[24:27], v[40:43], v[64:79]
    ds_read_b128 v[32:35], v6 offset:16384
    ds_read_b64_tr_b16 v[16:17], v4 offset:16384
    v_mfma_f32_32x32x16_bf16 v[80:95], v[24:27], v[44:47], v[80:95]
    ds_read_b64_tr_b16 v[18:19], v4 offset:18432
    ds_read_b128 v[36:39], v6 offset:20480
    v_mfma_f32_32x32x16_bf16 v[96:111], v[28:31], v[40:43], v[96:111]
    ds_read_b64_tr_b16 v[20:21], v5 offset:16384
    ds_read_b64_tr_b16 v[22:23], v5 offset:18432
    v_mfma_f32_32x32x16_bf16 v[112:127], v[28:31], v[44:47], v[112:127]
    s_waitcnt lgkmcnt(3)
    v_mfma_f32_32x32x16_bf16 v[64:79], v[16:19], v[32:35], v[64:79]
    ds_read_b128 v[40:43], v6 offset:17408
    ds_read_b64_tr_b16 v[24:25], v4 offset:20480
    s_waitcnt lgkmcnt(4)
    v_mfma_f32_32x32x16_bf16 v[80:95], v[16:19], v[36:39], v[80:95]
    ds_read_b64_tr_b16 v[26:27], v4 offset:22528
    ds_read_b128 v[44:47], v6 offset:21504
    s_waitcnt lgkmcnt(4)
    v_mfma_f32_32x32x16_bf16 v[96:111], v[20:23], v[32:35], v[96:111]
    ds_read_b64_tr_b16 v[28:29], v5 offset:20480
    ds_read_b64_tr_b16 v[30:31], v5 offset:22528
    v_mfma_f32_32x32x16_bf16 v[112:127], v[20:23], v[36:39], v[112:127]
    s_waitcnt lgkmcnt(3)
    v_mfma_f32_32x32x16_bf16 v[64:79], v[24:27], v[40:43], v[64:79]
    ds_read_b128 v[32:35], v6 offset:18432
    ds_read_b64_tr_b16 v[16:17], v4 offset:24576
    s_waitcnt lgkmcnt(4)
    v_mfma_f32_32x32x16_bf16 v[80:95], v[24:27], v[44:47], v[80:95]
    ds_read_b64_tr_b16 v[18:19], v4 offset:26624
    ds_read_b128 v[36:39], v6 offset:22528
    s_waitcnt lgkmcnt(4)
    v_mfma_f32_32x32x16_bf16 v[96:111], v[28:31], v[40:43], v[96:111]
    ds_read_b64_tr_b16 v[20:21], v5 offset:24576
    ds_read_b64_tr_b16 v[22:23], v5 offset:26624
    v_mfma_f32_32x32x16_bf16 v[112:127], v[28:31], v[44:47], v[112:127]
    s_waitcnt lgkmcnt(3)
    v_mfma_f32_32x32x16_bf16 v[64:79], v[16:19], v[32:35], v[64:79]
    ds_read_b128 v[40:43], v6 offset:19456
    ds_read_b64_tr_b16 v[24:25], v4 offset:28672
    s_waitcnt lgkmcnt(4)
    v_mfma_f32_32x32x16_bf16 v[80:95], v[16:19], v[36:39], v[80:95]
    ds_read_b64_tr_b16 v[26:27], v4 offset:30720
    ds_read_b128 v[44:47], v6 offset:23552
    s_waitcnt lgkmcnt(4)
    v_mfma_f32_32x32x16_bf16 v[96:111], v[20:23], v[32:35], v[96:111]
    ds_read_b64_tr_b16 v[28:29], v5 offset:28672
    ds_read_b64_tr_b16 v[30:31], v5 offset:30720
    v_mfma_f32_32x32x16_bf16 v[112:127], v[20:23], v[36:39], v[112:127]
    s_waitcnt lgkmcnt(0)
    s_barrier
    v_mfma_f32_32x32x16_bf16 v[64:79], v[24:27], v[40:43], v[64:79]
    ds_read_b128 v[32:35], v6 offset:32768
    ds_read_b64_tr_b16 v[16:17], v2
    v_mfma_f32_32x32x16_bf16 v[80:95], v[24:27], v[44:47], v[80:95]
    ds_read_b64_tr_b16 v[18:19], v2 offset:2048
    ds_read_b128 v[36:39], v6 offset:36864
    v_mfma_f32_32x32x16_bf16 v[96:111], v[28:31], v[40:43], v[96:111]
    ds_read_b64_tr_b16 v[20:21], v3
    ds_read_b64_tr_b16 v[22:23], v3 offset:2048
    v_mfma_f32_32x32x16_bf16 v[112:127], v[28:31], v[44:47], v[112:127]
    s_waitcnt lgkmcnt(3)
    v_mfma_f32_32x32x16_bf16 v[64:79], v[16:19], v[32:35], v[64:79]
    ds_read_b128 v[40:43], v6 offset:33792
    ds_read_b64_tr_b16 v[24:25], v2 offset:4096
    s_waitcnt lgkmcnt(4)
    v_mfma_f32_32x32x16_bf16 v[80:95], v[16:19], v[36:39], v[80:95]
    ds_read_b64_tr_b16 v[26:27], v2 offset:6144
    ds_read_b128 v[44:47], v6 offset:37888
    s_waitcnt lgkmcnt(4)
    v_mfma_f32_32x32x16_bf16 v[96:111], v[20:23], v[32:35], v[96:111]
    ds_read_b64_tr_b16 v[28:29], v3 offset:4096
    ds_read_b64_tr_b16 v[30:31], v3 offset:6144
    v_mfma_f32_32x32x16_bf16 v[112:127], v[20:23], v[36:39], v[112:127]
    s_waitcnt lgkmcnt(3)
    v_mfma_f32_32x32x16_bf16 v[64:79], v[24:27], v[40:43], v[64:79]
    ds_read_b128 v[32:35], v6 offset:34816
    ds_read_b64_tr_b16 v[16:17], v2 offset:8192
    s_waitcnt lgkmcnt(4)
    v_mfma_f32_32x32x16_bf16 v[80:95], v[24:27], v[44:47], v[80:95]
    ds_read_b64_tr_b16 v[18:19], v2 offset:10240
    ds_read_b128 v[36:39], v6 offset:38912
    s_waitcnt lgkmcnt(4)
    v_mfma_f32_32x32x16_bf16 v[96:111], v[28:31], v[40:43], v[96:111]
    ds_read_b64_tr_b16 v[20:21], v3 offset:8192
    ds_read_b64_tr_b16 v[22:23], v3 offset:10240
    v_mfma_f32_32x32x16_bf16 v[112:127], v[28:31], v[44:47], v[112:127]
    s_waitcnt lgkmcnt(3)
    v_mfma_f32_32x32x16_bf16 v[64:79], v[16:19], v[32:35], v[64:79]
    ds_read_b128 v[40:43], v6 offset:35840
    ds_read_b64_tr_b16 v[24:25], v2 offset:12288
    s_waitcnt lgkmcnt(4)
    v_mfma_f32_32x32x16_bf16 v[80:95], v[16:19], v[36:39], v[80:95]
    ds_read_b64_tr_b16 v[26:27], v2 offset:14336
    ds_read_b128 v[44:47], v6 offset:39936
    s_waitcnt lgkmcnt(4)
    v_mfma_f32_32x32x16_bf16 v[96:111], v[20:23], v[32:35], v[96:111]
    ds_read_b64_tr_b16 v[28:29], v3 offset:12288
    ds_read_b64_tr_b16 v[30:31], v3 offset:14336
    v_mfma_f32_32x32x16_bf16 v[112:127], v[20:23], v[36:39], v[112:127]
    s_waitcnt lgkmcnt(0)
    s_barrier
    v_mfma_f32_32x32x16_bf16 v[64:79], v[24:27], v[40:43], v[64:79]
    ds_read_b128 v[32:35], v6 offset:49152
    ds_read_b64_tr_b16 v[16:17], v2 offset:16384
    v_mfma_f32_32x32x16_bf16 v[80:95], v[24:27], v[44:47], v[80:95]
    ds_read_b64_tr_b16 v[18:19], v2 offset:18432
    ds_read_b128 v[36:39], v6 offset:53248
    v_mfma_f32_32x32x16_bf16 v[96:111], v[28:31], v[40:43], v[96:111]
    ds_read_b64_tr_b16 v[20:21], v3 offset:16384
    ds_read_b64_tr_b16 v[22:23], v3 offset:18432
    v_mfma_f32_32x32x16_bf16 v[112:127], v[28:31], v[44:47], v[112:127]
    s_waitcnt lgkmcnt(3)
    v_mfma_f32_32x32x16_bf16 v[64:79], v[16:19], v[32:35], v[64:79]
    ds_read_b128 v[40:43], v6 offset:50176
    ds_read_b64_tr_b16 v[24:25], v2 offset:20480
    s_waitcnt lgkmcnt(4)
    v_mfma_f32_32x32x16_bf16 v[80:95], v[16:19], v[36:39], v[80:95]
    ds_read_b64_tr_b16 v[26:27], v2 offset:22528
    ds_read_b128 v[44:47], v6 offset:54272
    s_waitcnt lgkmcnt(4)
    v_mfma_f32_32x32x16_bf16 v[96:111], v[20:23], v[32:35], v[96:111]
    ds_read_b64_tr_b16 v[28:29], v3 offset:20480
    ds_read_b64_tr_b16 v[30:31], v3 offset:22528
    v_mfma_f32_32x32x16_bf16 v[112:127], v[20:23], v[36:39], v[112:127]
    s_waitcnt lgkmcnt(3)
    v_mfma_f32_32x32x16_bf16 v[64:79], v[24:27], v[40:43], v[64:79]
    ds_read_b128 v[32:35], v6 offset:51200
    ds_read_b64_tr_b16 v[16:17], v2 offset:24576
    s_waitcnt lgkmcnt(4)
    v_mfma_f32_32x32x16_bf16 v[80:95], v[24:27], v[44:47], v[80:95]
    ds_read_b64_tr_b16 v[18:19], v2 offset:26624
    ds_read_b128 v[36:39], v6 offset:55296
    s_waitcnt lgkmcnt(4)
    v_mfma_f32_32x32x16_bf16 v[96:111], v[28:31], v[40:43], v[96:111]
    ds_read_b64_tr_b16 v[20:21], v3 offset:24576
    ds_read_b64_tr_b16 v[22:23], v3 offset:26624
    v_mfma_f32_32x32x16_bf16 v[112:127], v[28:31], v[44:47], v[112:127]
    s_waitcnt lgkmcnt(3)
    v_mfma_f32_32x32x16_bf16 v[64:79], v[16:19], v[32:35], v[64:79]
    ds_read_b128 v[40:43], v6 offset:52224
    ds_read_b64_tr_b16 v[24:25], v2 offset:28672
    s_waitcnt lgkmcnt(4)
    v_mfma_f32_32x32x16_bf16 v[80:95], v[16:19], v[36:39], v[80:95]
    ds_read_b64_tr_b16 v[26:27], v2 offset:30720
    ds_read_b128 v[44:47], v6 offset:56320
    s_waitcnt lgkmcnt(4)
    v_mfma_f32_32x32x16_bf16 v[96:111], v[20:23], v[32:35], v[96:111]
    ds_read_b64_tr_b16 v[28:29], v3 offset:28672
    ds_read_b64_tr_b16 v[30:31], v3 offset:30720
    v_mfma_f32_32x32x16_bf16 v[112:127], v[20:23], v[36:39], v[112:127]
    s_waitcnt lgkmcnt(0)
    s_barrier
    v_mfma_f32_32x32x16_bf16 v[64:79], v[24:27], v[40:43], v[64:79]
    ds_read_b128 v[32:35], v6
    ds_read_b64_tr_b16 v[16:17], v2 offset:49152
    v_mfma_f32_32x32x16_bf16 v[80:95], v[24:27], v[44:47], v[80:95]
    ds_read_b64_tr_b16 v[18:19], v2 offset:51200
    ds_read_b128 v[36:39], v6 offset:4096
    v_mfma_f32_32x32x16_bf16 v[96:111], v[28:31], v[40:43], v[96:111]
    ds_read_b64_tr_b16 v[20:21], v3 offset:49152
    ds_read_b64_tr_b16 v[22:23], v3 offset:51200
    v_mfma_f32_32x32x16_bf16 v[112:127], v[28:31], v[44:47], v[112:127]
    s_waitcnt lgkmcnt(3)
    v_mfma_f32_32x32x16_bf16 v[64:79], v[16:19], v[32:35], v[64:79]
    ds_read_b128 v[40:43], v6 offset:1024
    ds_read_b64_tr_b16 v[24:25], v2 offset:53248
    s_waitcnt lgkmcnt(4)
    v_mfma_f32_32x32x16_bf16 v[80:95], v[16:19], v[36:39], v[80:95]
    ds_read_b64_tr_b16 v[26:27], v2 offset:55296
    ds_read_b128 v[44:47], v6 offset:5120
    s_waitcnt lgkmcnt(4)
    v_mfma_f32_32x32x16_bf16 v[96:111], v[20:23], v[32:35], v[96:111]
    ds_read_b64_tr_b16 v[28:29], v3 offset:53248
    ds_read_b64_tr_b16 v[30:31], v3 offset:55296
    v_mfma_f32_32x32x16_bf16 v[112:127], v[20:23], v[36:39], v[112:127]
    s_waitcnt lgkmcnt(3)
    v_mfma_f32_32x32x16_bf16 v[64:79], v[24:27], v[40:43], v[64:79]
    ds_read_b128 v[32:35], v6 offset:2048
    ds_read_b64_tr_b16 v[16:17], v2 offset:57344
    s_waitcnt lgkmcnt(4)
    v_mfma_f32_32x32x16_bf16 v[80:95], v[24:27], v[44:47], v[80:95]
    ds_read_b64_tr_b16 v[18:19], v2 offset:59392
    ds_read_b128 v[36:39], v6 offset:6144
    s_waitcnt lgkmcnt(4)
    v_mfma_f32_32x32x16_bf16 v[96:111], v[28:31], v[40:43], v[96:111]
    ds_read_b64_tr_b16 v[20:21], v3 offset:57344
    ds_read_b64_tr_b16 v[22:23], v3 offset:59392
    v_mfma_f32_32x32x16_bf16 v[112:127], v[28:31], v[44:47], v[112:127]
    s_waitcnt lgkmcnt(3)
    v_mfma_f32_32x32x16_bf16 v[64:79], v[16:19], v[32:35], v[64:79]
    ds_read_b128 v[40:43], v6 offset:3072
    ds_read_b64_tr_b16 v[24:25], v2 offset:61440
    s_waitcnt lgkmcnt(4)
    v_mfma_f32_32x32x16_bf16 v[80:95], v[16:19], v[36:39], v[80:95]
    ds_read_b64_tr_b16 v[26:27], v2 offset:63488
    ds_read_b128 v[44:47], v6 offset:7168
    s_waitcnt lgkmcnt(4)
    v_mfma_f32_32x32x16_bf16 v[96:111], v[20:23], v[32:35], v[96:111]
    ds_read_b64_tr_b16 v[28:29], v3 offset:61440
    ds_read_b64_tr_b16 v[30:31], v3 offset:63488
    v_mfma_f32_32x32x16_bf16 v[112:127], v[20:23], v[36:39], v[112:127]
    s_waitcnt lgkmcnt(0)
    s_barrier
    v_mfma_f32_32x32x16_bf16 v[64:79], v[24:27], v[40:43], v[64:79]
    ds_read_b128 v[32:35], v6 offset:16384
    ds_read_b64_tr_b16 v[16:17], v4 offset:16384
    v_mfma_f32_32x32x16_bf16 v[80:95], v[24:27], v[44:47], v[80:95]
    ds_read_b64_tr_b16 v[18:19], v4 offset:18432
    ds_read_b128 v[36:39], v6 offset:20480
    v_mfma_f32_32x32x16_bf16 v[96:111], v[28:31], v[40:43], v[96:111]
    ds_read_b64_tr_b16 v[20:21], v5 offset:16384
    ds_read_b64_tr_b16 v[22:23], v5 offset:18432
    v_mfma_f32_32x32x16_bf16 v[112:127], v[28:31], v[44:47], v[112:127]
    s_waitcnt lgkmcnt(3)
    v_mfma_f32_32x32x16_bf16 v[64:79], v[16:19], v[32:35], v[64:79]
    ds_read_b128 v[40:43], v6 offset:17408
    ds_read_b64_tr_b16 v[24:25], v4 offset:20480
    s_waitcnt lgkmcnt(4)
    v_mfma_f32_32x32x16_bf16 v[80:95], v[16:19], v[36:39], v[80:95]
    ds_read_b64_tr_b16 v[26:27], v4 offset:22528
    ds_read_b128 v[44:47], v6 offset:21504
    s_waitcnt lgkmcnt(4)
    v_mfma_f32_32x32x16_bf16 v[96:111], v[20:23], v[32:35], v[96:111]
    ds_read_b64_tr_b16 v[28:29], v5 offset:20480
    ds_read_b64_tr_b16 v[30:31], v5 offset:22528
    v_mfma_f32_32x32x16_bf16 v[112:127], v[20:23], v[36:39], v[112:127]
    s_waitcnt lgkmcnt(3)
    v_mfma_f32_32x32x16_bf16 v[64:79], v[24:27], v[40:43], v[64:79]
    ds_read_b128 v[32:35], v6 offset:18432
    ds_read_b64_tr_b16 v[16:17], v4 offset:24576
    s_waitcnt lgkmcnt(4)
    v_mfma_f32_32x32x16_bf16 v[80:95], v[24:27], v[44:47], v[80:95]
    ds_read_b64_tr_b16 v[18:19], v4 offset:26624
    ds_read_b128 v[36:39], v6 offset:22528
    s_waitcnt lgkmcnt(4)
    v_mfma_f32_32x32x16_bf16 v[96:111], v[28:31], v[40:43], v[96:111]
    ds_read_b64_tr_b16 v[20:21], v5 offset:24576
    ds_read_b64_tr_b16 v[22:23], v5 offset:26624
    v_mfma_f32_32x32x16_bf16 v[112:127], v[28:31], v[44:47], v[112:127]
    s_waitcnt lgkmcnt(3)
    v_mfma_f32_32x32x16_bf16 v[64:79], v[16:19], v[32:35], v[64:79]
    ds_read_b128 v[40:43], v6 offset:19456
    ds_read_b64_tr_b16 v[24:25], v4 offset:28672
    s_waitcnt lgkmcnt(4)
    v_mfma_f32_32x32x16_bf16 v[80:95], v[16:19], v[36:39], v[80:95]
    ds_read_b64_tr_b16 v[26:27], v4 offset:30720
    ds_read_b128 v[44:47], v6 offset:23552
    s_waitcnt lgkmcnt(4)
    v_mfma_f32_32x32x16_bf16 v[96:111], v[20:23], v[32:35], v[96:111]
    ds_read_b64_tr_b16 v[28:29], v5 offset:28672
    ds_read_b64_tr_b16 v[30:31], v5 offset:30720
    v_mfma_f32_32x32x16_bf16 v[112:127], v[20:23], v[36:39], v[112:127]
    s_waitcnt lgkmcnt(0)
    s_barrier
    v_mfma_f32_32x32x16_bf16 v[64:79], v[24:27], v[40:43], v[64:79]
    ds_read_b128 v[32:35], v6 offset:32768
    ds_read_b64_tr_b16 v[16:17], v2
    v_mfma_f32_32x32x16_bf16 v[80:95], v[24:27], v[44:47], v[80:95]
    ds_read_b64_tr_b16 v[18:19], v2 offset:2048
    ds_read_b128 v[36:39], v6 offset:36864
    v_mfma_f32_32x32x16_bf16 v[96:111], v[28:31], v[40:43], v[96:111]
    ds_read_b64_tr_b16 v[20:21], v3
    ds_read_b64_tr_b16 v[22:23], v3 offset:2048
    v_mfma_f32_32x32x16_bf16 v[112:127], v[28:31], v[44:47], v[112:127]
    s_waitcnt lgkmcnt(3)
    v_mfma_f32_32x32x16_bf16 v[64:79], v[16:19], v[32:35], v[64:79]
    ds_read_b128 v[40:43], v6 offset:33792
    ds_read_b64_tr_b16 v[24:25], v2 offset:4096
    s_waitcnt lgkmcnt(4)
    v_mfma_f32_32x32x16_bf16 v[80:95], v[16:19], v[36:39], v[80:95]
    ds_read_b64_tr_b16 v[26:27], v2 offset:6144
    ds_read_b128 v[44:47], v6 offset:37888
    s_waitcnt lgkmcnt(4)
    v_mfma_f32_32x32x16_bf16 v[96:111], v[20:23], v[32:35], v[96:111]
    ds_read_b64_tr_b16 v[28:29], v3 offset:4096
    ds_read_b64_tr_b16 v[30:31], v3 offset:6144
    v_mfma_f32_32x32x16_bf16 v[112:127], v[20:23], v[36:39], v[112:127]
    s_waitcnt lgkmcnt(3)
    v_mfma_f32_32x32x16_bf16 v[64:79], v[24:27], v[40:43], v[64:79]
    ds_read_b128 v[32:35], v6 offset:34816
    ds_read_b64_tr_b16 v[16:17], v2 offset:8192
    s_waitcnt lgkmcnt(4)
    v_mfma_f32_32x32x16_bf16 v[80:95], v[24:27], v[44:47], v[80:95]
    ds_read_b64_tr_b16 v[18:19], v2 offset:10240
    ds_read_b128 v[36:39], v6 offset:38912
    s_waitcnt lgkmcnt(4)
    v_mfma_f32_32x32x16_bf16 v[96:111], v[28:31], v[40:43], v[96:111]
    ds_read_b64_tr_b16 v[20:21], v3 offset:8192
    ds_read_b64_tr_b16 v[22:23], v3 offset:10240
    v_mfma_f32_32x32x16_bf16 v[112:127], v[28:31], v[44:47], v[112:127]
    s_waitcnt lgkmcnt(3)
    v_mfma_f32_32x32x16_bf16 v[64:79], v[16:19], v[32:35], v[64:79]
    ds_read_b128 v[40:43], v6 offset:35840
    ds_read_b64_tr_b16 v[24:25], v2 offset:12288
    s_waitcnt lgkmcnt(4)
    v_mfma_f32_32x32x16_bf16 v[80:95], v[16:19], v[36:39], v[80:95]
    ds_read_b64_tr_b16 v[26:27], v2 offset:14336
    ds_read_b128 v[44:47], v6 offset:39936
    s_waitcnt lgkmcnt(4)
    v_mfma_f32_32x32x16_bf16 v[96:111], v[20:23], v[32:35], v[96:111]
    ds_read_b64_tr_b16 v[28:29], v3 offset:12288
    ds_read_b64_tr_b16 v[30:31], v3 offset:14336
    v_mfma_f32_32x32x16_bf16 v[112:127], v[20:23], v[36:39], v[112:127]
    s_waitcnt lgkmcnt(0)
    s_barrier
    v_mfma_f32_32x32x16_bf16 v[64:79], v[24:27], v[40:43], v[64:79]
    ds_read_b128 v[32:35], v6 offset:49152
    ds_read_b64_tr_b16 v[16:17], v2 offset:16384
    v_mfma_f32_32x32x16_bf16 v[80:95], v[24:27], v[44:47], v[80:95]
    ds_read_b64_tr_b16 v[18:19], v2 offset:18432
    ds_read_b128 v[36:39], v6 offset:53248
    v_mfma_f32_32x32x16_bf16 v[96:111], v[28:31], v[40:43], v[96:111]
    ds_read_b64_tr_b16 v[20:21], v3 offset:16384
    ds_read_b64_tr_b16 v[22:23], v3 offset:18432
    v_mfma_f32_32x32x16_bf16 v[112:127], v[28:31], v[44:47], v[112:127]
    s_waitcnt lgkmcnt(3)
    v_mfma_f32_32x32x16_bf16 v[64:79], v[16:19], v[32:35], v[64:79]
    ds_read_b128 v[40:43], v6 offset:50176
    ds_read_b64_tr_b16 v[24:25], v2 offset:20480
    s_waitcnt lgkmcnt(4)
    v_mfma_f32_32x32x16_bf16 v[80:95], v[16:19], v[36:39], v[80:95]
    ds_read_b64_tr_b16 v[26:27], v2 offset:22528
    ds_read_b128 v[44:47], v6 offset:54272
    s_waitcnt lgkmcnt(4)
    v_mfma_f32_32x32x16_bf16 v[96:111], v[20:23], v[32:35], v[96:111]
    ds_read_b64_tr_b16 v[28:29], v3 offset:20480
    ds_read_b64_tr_b16 v[30:31], v3 offset:22528
    v_mfma_f32_32x32x16_bf16 v[112:127], v[20:23], v[36:39], v[112:127]
    s_waitcnt lgkmcnt(3)
    v_mfma_f32_32x32x16_bf16 v[64:79], v[24:27], v[40:43], v[64:79]
    ds_read_b128 v[32:35], v6 offset:51200
    ds_read_b64_tr_b16 v[16:17], v2 offset:24576
    s_waitcnt lgkmcnt(4)
    v_mfma_f32_32x32x16_bf16 v[80:95], v[24:27], v[44:47], v[80:95]
    ds_read_b64_tr_b16 v[18:19], v2 offset:26624
    ds_read_b128 v[36:39], v6 offset:55296
    s_waitcnt lgkmcnt(4)
    v_mfma_f32_32x32x16_bf16 v[96:111], v[28:31], v[40:43], v[96:111]
    ds_read_b64_tr_b16 v[20:21], v3 offset:24576
    ds_read_b64_tr_b16 v[22:23], v3 offset:26624
    v_mfma_f32_32x32x16_bf16 v[112:127], v[28:31], v[44:47], v[112:127]
    s_waitcnt lgkmcnt(3)
    v_mfma_f32_32x32x16_bf16 v[64:79], v[16:19], v[32:35], v[64:79]
    ds_read_b128 v[40:43], v6 offset:52224
    ds_read_b64_tr_b16 v[24:25], v2 offset:28672
    s_waitcnt lgkmcnt(4)
    v_mfma_f32_32x32x16_bf16 v[80:95], v[16:19], v[36:39], v[80:95]
    ds_read_b64_tr_b16 v[26:27], v2 offset:30720
    ds_read_b128 v[44:47], v6 offset:56320
    s_waitcnt lgkmcnt(4)
    v_mfma_f32_32x32x16_bf16 v[96:111], v[20:23], v[32:35], v[96:111]
    ds_read_b64_tr_b16 v[28:29], v3 offset:28672
    ds_read_b64_tr_b16 v[30:31], v3 offset:30720
    v_mfma_f32_32x32x16_bf16 v[112:127], v[20:23], v[36:39], v[112:127]
    s_waitcnt lgkmcnt(0)
    s_barrier
    v_mfma_f32_32x32x16_bf16 v[64:79], v[24:27], v[40:43], v[64:79]
    ds_read_b128 v[32:35], v6
    ds_read_b64_tr_b16 v[16:17], v2 offset:49152
    v_mfma_f32_32x32x16_bf16 v[80:95], v[24:27], v[44:47], v[80:95]
    ds_read_b64_tr_b16 v[18:19], v2 offset:51200
    ds_read_b128 v[36:39], v6 offset:4096
    v_mfma_f32_32x32x16_bf16 v[96:111], v[28:31], v[40:43], v[96:111]
    ds_read_b64_tr_b16 v[20:21], v3 offset:49152
    ds_read_b64_tr_b16 v[22:23], v3 offset:51200
    v_mfma_f32_32x32x16_bf16 v[112:127], v[28:31], v[44:47], v[112:127]
    s_waitcnt lgkmcnt(3)
    v_mfma_f32_32x32x16_bf16 v[64:79], v[16:19], v[32:35], v[64:79]
    ds_read_b128 v[40:43], v6 offset:1024
    ds_read_b64_tr_b16 v[24:25], v2 offset:53248
    s_waitcnt lgkmcnt(4)
    v_mfma_f32_32x32x16_bf16 v[80:95], v[16:19], v[36:39], v[80:95]
    ds_read_b64_tr_b16 v[26:27], v2 offset:55296
    ds_read_b128 v[44:47], v6 offset:5120
    s_waitcnt lgkmcnt(4)
    v_mfma_f32_32x32x16_bf16 v[96:111], v[20:23], v[32:35], v[96:111]
    ds_read_b64_tr_b16 v[28:29], v3 offset:53248
    ds_read_b64_tr_b16 v[30:31], v3 offset:55296
    v_mfma_f32_32x32x16_bf16 v[112:127], v[20:23], v[36:39], v[112:127]
    s_waitcnt lgkmcnt(3)
    v_mfma_f32_32x32x16_bf16 v[64:79], v[24:27], v[40:43], v[64:79]
    ds_read_b128 v[32:35], v6 offset:2048
    ds_read_b64_tr_b16 v[16:17], v2 offset:57344
    s_waitcnt lgkmcnt(4)
    v_mfma_f32_32x32x16_bf16 v[80:95], v[24:27], v[44:47], v[80:95]
    ds_read_b64_tr_b16 v[18:19], v2 offset:59392
    ds_read_b128 v[36:39], v6 offset:6144
    s_waitcnt lgkmcnt(4)
    v_mfma_f32_32x32x16_bf16 v[96:111], v[28:31], v[40:43], v[96:111]
    ds_read_b64_tr_b16 v[20:21], v3 offset:57344
    ds_read_b64_tr_b16 v[22:23], v3 offset:59392
    v_mfma_f32_32x32x16_bf16 v[112:127], v[28:31], v[44:47], v[112:127]
    s_waitcnt lgkmcnt(3)
    v_mfma_f32_32x32x16_bf16 v[64:79], v[16:19], v[32:35], v[64:79]
    ds_read_b128 v[40:43], v6 offset:3072
    ds_read_b64_tr_b16 v[24:25], v2 offset:61440
    s_waitcnt lgkmcnt(4)
    v_mfma_f32_32x32x16_bf16 v[80:95], v[16:19], v[36:39], v[80:95]
    ds_read_b64_tr_b16 v[26:27], v2 offset:63488
    ds_read_b128 v[44:47], v6 offset:7168
    s_waitcnt lgkmcnt(4)
    v_mfma_f32_32x32x16_bf16 v[96:111], v[20:23], v[32:35], v[96:111]
    ds_read_b64_tr_b16 v[28:29], v3 offset:61440
    ds_read_b64_tr_b16 v[30:31], v3 offset:63488
    v_mfma_f32_32x32x16_bf16 v[112:127], v[20:23], v[36:39], v[112:127]
    s_waitcnt lgkmcnt(0)
    s_barrier
    v_mfma_f32_32x32x16_bf16 v[64:79], v[24:27], v[40:43], v[64:79]
    ds_read_b128 v[32:35], v6 offset:16384
    ds_read_b64_tr_b16 v[16:17], v4 offset:16384
    v_mfma_f32_32x32x16_bf16 v[80:95], v[24:27], v[44:47], v[80:95]
    ds_read_b64_tr_b16 v[18:19], v4 offset:18432
    ds_read_b128 v[36:39], v6 offset:20480
    v_mfma_f32_32x32x16_bf16 v[96:111], v[28:31], v[40:43], v[96:111]
    ds_read_b64_tr_b16 v[20:21], v5 offset:16384
    ds_read_b64_tr_b16 v[22:23], v5 offset:18432
    v_mfma_f32_32x32x16_bf16 v[112:127], v[28:31], v[44:47], v[112:127]
    s_waitcnt lgkmcnt(3)
    v_mfma_f32_32x32x16_bf16 v[64:79], v[16:19], v[32:35], v[64:79]
    ds_read_b128 v[40:43], v6 offset:17408
    ds_read_b64_tr_b16 v[24:25], v4 offset:20480
    s_waitcnt lgkmcnt(4)
    v_mfma_f32_32x32x16_bf16 v[80:95], v[16:19], v[36:39], v[80:95]
    ds_read_b64_tr_b16 v[26:27], v4 offset:22528
    ds_read_b128 v[44:47], v6 offset:21504
    s_waitcnt lgkmcnt(4)
    v_mfma_f32_32x32x16_bf16 v[96:111], v[20:23], v[32:35], v[96:111]
    ds_read_b64_tr_b16 v[28:29], v5 offset:20480
    ds_read_b64_tr_b16 v[30:31], v5 offset:22528
    v_mfma_f32_32x32x16_bf16 v[112:127], v[20:23], v[36:39], v[112:127]
    s_waitcnt lgkmcnt(3)
    v_mfma_f32_32x32x16_bf16 v[64:79], v[24:27], v[40:43], v[64:79]
    ds_read_b128 v[32:35], v6 offset:18432
    ds_read_b64_tr_b16 v[16:17], v4 offset:24576
    s_waitcnt lgkmcnt(4)
    v_mfma_f32_32x32x16_bf16 v[80:95], v[24:27], v[44:47], v[80:95]
    ds_read_b64_tr_b16 v[18:19], v4 offset:26624
    ds_read_b128 v[36:39], v6 offset:22528
    s_waitcnt lgkmcnt(4)
    v_mfma_f32_32x32x16_bf16 v[96:111], v[28:31], v[40:43], v[96:111]
    ds_read_b64_tr_b16 v[20:21], v5 offset:24576
    ds_read_b64_tr_b16 v[22:23], v5 offset:26624
    v_mfma_f32_32x32x16_bf16 v[112:127], v[28:31], v[44:47], v[112:127]
    s_waitcnt lgkmcnt(3)
    v_mfma_f32_32x32x16_bf16 v[64:79], v[16:19], v[32:35], v[64:79]
    ds_read_b128 v[40:43], v6 offset:19456
    ds_read_b64_tr_b16 v[24:25], v4 offset:28672
    s_waitcnt lgkmcnt(4)
    v_mfma_f32_32x32x16_bf16 v[80:95], v[16:19], v[36:39], v[80:95]
    ds_read_b64_tr_b16 v[26:27], v4 offset:30720
    ds_read_b128 v[44:47], v6 offset:23552
    s_waitcnt lgkmcnt(4)
    v_mfma_f32_32x32x16_bf16 v[96:111], v[20:23], v[32:35], v[96:111]
    ds_read_b64_tr_b16 v[28:29], v5 offset:28672
    ds_read_b64_tr_b16 v[30:31], v5 offset:30720
    v_mfma_f32_32x32x16_bf16 v[112:127], v[20:23], v[36:39], v[112:127]
    s_waitcnt lgkmcnt(0)
    s_barrier
    v_mfma_f32_32x32x16_bf16 v[64:79], v[24:27], v[40:43], v[64:79]
    ds_read_b128 v[32:35], v6 offset:32768
    ds_read_b64_tr_b16 v[16:17], v2
    v_mfma_f32_32x32x16_bf16 v[80:95], v[24:27], v[44:47], v[80:95]
    ds_read_b64_tr_b16 v[18:19], v2 offset:2048
    ds_read_b128 v[36:39], v6 offset:36864
    v_mfma_f32_32x32x16_bf16 v[96:111], v[28:31], v[40:43], v[96:111]
    ds_read_b64_tr_b16 v[20:21], v3
    ds_read_b64_tr_b16 v[22:23], v3 offset:2048
    v_mfma_f32_32x32x16_bf16 v[112:127], v[28:31], v[44:47], v[112:127]
    s_waitcnt lgkmcnt(3)
    v_mfma_f32_32x32x16_bf16 v[64:79], v[16:19], v[32:35], v[64:79]
    ds_read_b128 v[40:43], v6 offset:33792
    ds_read_b64_tr_b16 v[24:25], v2 offset:4096
    s_waitcnt lgkmcnt(4)
    v_mfma_f32_32x32x16_bf16 v[80:95], v[16:19], v[36:39], v[80:95]
    ds_read_b64_tr_b16 v[26:27], v2 offset:6144
    ds_read_b128 v[44:47], v6 offset:37888
    s_waitcnt lgkmcnt(4)
    v_mfma_f32_32x32x16_bf16 v[96:111], v[20:23], v[32:35], v[96:111]
    ds_read_b64_tr_b16 v[28:29], v3 offset:4096
    ds_read_b64_tr_b16 v[30:31], v3 offset:6144
    v_mfma_f32_32x32x16_bf16 v[112:127], v[20:23], v[36:39], v[112:127]
    s_waitcnt lgkmcnt(3)
    v_mfma_f32_32x32x16_bf16 v[64:79], v[24:27], v[40:43], v[64:79]
    ds_read_b128 v[32:35], v6 offset:34816
    ds_read_b64_tr_b16 v[16:17], v2 offset:8192
    s_waitcnt lgkmcnt(4)
    v_mfma_f32_32x32x16_bf16 v[80:95], v[24:27], v[44:47], v[80:95]
    ds_read_b64_tr_b16 v[18:19], v2 offset:10240
    ds_read_b128 v[36:39], v6 offset:38912
    s_waitcnt lgkmcnt(4)
    v_mfma_f32_32x32x16_bf16 v[96:111], v[28:31], v[40:43], v[96:111]
    ds_read_b64_tr_b16 v[20:21], v3 offset:8192
    ds_read_b64_tr_b16 v[22:23], v3 offset:10240
    v_mfma_f32_32x32x16_bf16 v[112:127], v[28:31], v[44:47], v[112:127]
    s_waitcnt lgkmcnt(3)
    v_mfma_f32_32x32x16_bf16 v[64:79], v[16:19], v[32:35], v[64:79]
    ds_read_b128 v[40:43], v6 offset:35840
    ds_read_b64_tr_b16 v[24:25], v2 offset:12288
    s_waitcnt lgkmcnt(4)
    v_mfma_f32_32x32x16_bf16 v[80:95], v[16:19], v[36:39], v[80:95]
    ds_read_b64_tr_b16 v[26:27], v2 offset:14336
    ds_read_b128 v[44:47], v6 offset:39936
    s_waitcnt lgkmcnt(4)
    v_mfma_f32_32x32x16_bf16 v[96:111], v[20:23], v[32:35], v[96:111]
    ds_read_b64_tr_b16 v[28:29], v3 offset:12288
    ds_read_b64_tr_b16 v[30:31], v3 offset:14336
    v_mfma_f32_32x32x16_bf16 v[112:127], v[20:23], v[36:39], v[112:127]
    s_waitcnt lgkmcnt(0)
    s_barrier
    v_mfma_f32_32x32x16_bf16 v[64:79], v[24:27], v[40:43], v[64:79]
    ds_read_b128 v[32:35], v6 offset:49152
    ds_read_b64_tr_b16 v[16:17], v2 offset:16384
    v_mfma_f32_32x32x16_bf16 v[80:95], v[24:27], v[44:47], v[80:95]
    ds_read_b64_tr_b16 v[18:19], v2 offset:18432
    ds_read_b128 v[36:39], v6 offset:53248
    v_mfma_f32_32x32x16_bf16 v[96:111], v[28:31], v[40:43], v[96:111]
    ds_read_b64_tr_b16 v[20:21], v3 offset:16384
    ds_read_b64_tr_b16 v[22:23], v3 offset:18432
    v_mfma_f32_32x32x16_bf16 v[112:127], v[28:31], v[44:47], v[112:127]
    s_waitcnt lgkmcnt(3)
    v_mfma_f32_32x32x16_bf16 v[64:79], v[16:19], v[32:35], v[64:79]
    ds_read_b128 v[40:43], v6 offset:50176
    ds_read_b64_tr_b16 v[24:25], v2 offset:20480
    s_waitcnt lgkmcnt(4)
    v_mfma_f32_32x32x16_bf16 v[80:95], v[16:19], v[36:39], v[80:95]
    ds_read_b64_tr_b16 v[26:27], v2 offset:22528
    ds_read_b128 v[44:47], v6 offset:54272
    s_waitcnt lgkmcnt(4)
    v_mfma_f32_32x32x16_bf16 v[96:111], v[20:23], v[32:35], v[96:111]
    ds_read_b64_tr_b16 v[28:29], v3 offset:20480
    ds_read_b64_tr_b16 v[30:31], v3 offset:22528
    v_mfma_f32_32x32x16_bf16 v[112:127], v[20:23], v[36:39], v[112:127]
    s_waitcnt lgkmcnt(3)
    v_mfma_f32_32x32x16_bf16 v[64:79], v[24:27], v[40:43], v[64:79]
    ds_read_b128 v[32:35], v6 offset:51200
    ds_read_b64_tr_b16 v[16:17], v2 offset:24576
    s_waitcnt lgkmcnt(4)
    v_mfma_f32_32x32x16_bf16 v[80:95], v[24:27], v[44:47], v[80:95]
    ds_read_b64_tr_b16 v[18:19], v2 offset:26624
    ds_read_b128 v[36:39], v6 offset:55296
    s_waitcnt lgkmcnt(4)
    v_mfma_f32_32x32x16_bf16 v[96:111], v[28:31], v[40:43], v[96:111]
    ds_read_b64_tr_b16 v[20:21], v3 offset:24576
    ds_read_b64_tr_b16 v[22:23], v3 offset:26624
    v_mfma_f32_32x32x16_bf16 v[112:127], v[28:31], v[44:47], v[112:127]
    s_waitcnt lgkmcnt(3)
    v_mfma_f32_32x32x16_bf16 v[64:79], v[16:19], v[32:35], v[64:79]
    ds_read_b128 v[40:43], v6 offset:52224
    ds_read_b64_tr_b16 v[24:25], v2 offset:28672
    s_waitcnt lgkmcnt(4)
    v_mfma_f32_32x32x16_bf16 v[80:95], v[16:19], v[36:39], v[80:95]
    ds_read_b64_tr_b16 v[26:27], v2 offset:30720
    ds_read_b128 v[44:47], v6 offset:56320
    s_waitcnt lgkmcnt(4)
    v_mfma_f32_32x32x16_bf16 v[96:111], v[20:23], v[32:35], v[96:111]
    ds_read_b64_tr_b16 v[28:29], v3 offset:28672
    ds_read_b64_tr_b16 v[30:31], v3 offset:30720
    v_mfma_f32_32x32x16_bf16 v[112:127], v[20:23], v[36:39], v[112:127]
    s_waitcnt lgkmcnt(0)
    s_barrier
    v_mfma_f32_32x32x16_bf16 v[64:79], v[24:27], v[40:43], v[64:79]
    ds_read_b128 v[32:35], v6
    ds_read_b64_tr_b16 v[16:17], v2 offset:49152
    v_mfma_f32_32x32x16_bf16 v[80:95], v[24:27], v[44:47], v[80:95]
    ds_read_b64_tr_b16 v[18:19], v2 offset:51200
    ds_read_b128 v[36:39], v6 offset:4096
    v_mfma_f32_32x32x16_bf16 v[96:111], v[28:31], v[40:43], v[96:111]
    ds_read_b64_tr_b16 v[20:21], v3 offset:49152
    ds_read_b64_tr_b16 v[22:23], v3 offset:51200
    v_mfma_f32_32x32x16_bf16 v[112:127], v[28:31], v[44:47], v[112:127]
    s_waitcnt lgkmcnt(3)
    v_mfma_f32_32x32x16_bf16 v[64:79], v[16:19], v[32:35], v[64:79]
    ds_read_b128 v[40:43], v6 offset:1024
    ds_read_b64_tr_b16 v[24:25], v2 offset:53248
    s_waitcnt lgkmcnt(4)
    v_mfma_f32_32x32x16_bf16 v[80:95], v[16:19], v[36:39], v[80:95]
    ds_read_b64_tr_b16 v[26:27], v2 offset:55296
    ds_read_b128 v[44:47], v6 offset:5120
    s_waitcnt lgkmcnt(4)
    v_mfma_f32_32x32x16_bf16 v[96:111], v[20:23], v[32:35], v[96:111]
    ds_read_b64_tr_b16 v[28:29], v3 offset:53248
    ds_read_b64_tr_b16 v[30:31], v3 offset:55296
    v_mfma_f32_32x32x16_bf16 v[112:127], v[20:23], v[36:39], v[112:127]
    s_waitcnt lgkmcnt(3)
    v_mfma_f32_32x32x16_bf16 v[64:79], v[24:27], v[40:43], v[64:79]
    ds_read_b128 v[32:35], v6 offset:2048
    ds_read_b64_tr_b16 v[16:17], v2 offset:57344
    s_waitcnt lgkmcnt(4)
    v_mfma_f32_32x32x16_bf16 v[80:95], v[24:27], v[44:47], v[80:95]
    ds_read_b64_tr_b16 v[18:19], v2 offset:59392
    ds_read_b128 v[36:39], v6 offset:6144
    s_waitcnt lgkmcnt(4)
    v_mfma_f32_32x32x16_bf16 v[96:111], v[28:31], v[40:43], v[96:111]
    ds_read_b64_tr_b16 v[20:21], v3 offset:57344
    ds_read_b64_tr_b16 v[22:23], v3 offset:59392
    v_mfma_f32_32x32x16_bf16 v[112:127], v[28:31], v[44:47], v[112:127]
    s_waitcnt lgkmcnt(3)
    v_mfma_f32_32x32x16_bf16 v[64:79], v[16:19], v[32:35], v[64:79]
    ds_read_b128 v[40:43], v6 offset:3072
    ds_read_b64_tr_b16 v[24:25], v2 offset:61440
    s_waitcnt lgkmcnt(4)
    v_mfma_f32_32x32x16_bf16 v[80:95], v[16:19], v[36:39], v[80:95]
    ds_read_b64_tr_b16 v[26:27], v2 offset:63488
    ds_read_b128 v[44:47], v6 offset:7168
    s_waitcnt lgkmcnt(4)
    v_mfma_f32_32x32x16_bf16 v[96:111], v[20:23], v[32:35], v[96:111]
    ds_read_b64_tr_b16 v[28:29], v3 offset:61440
    ds_read_b64_tr_b16 v[30:31], v3 offset:63488
    v_mfma_f32_32x32x16_bf16 v[112:127], v[20:23], v[36:39], v[112:127]
    s_waitcnt lgkmcnt(0)
    s_barrier
    v_mfma_f32_32x32x16_bf16 v[64:79], v[24:27], v[40:43], v[64:79]
    ds_read_b128 v[32:35], v6 offset:16384
    ds_read_b64_tr_b16 v[16:17], v4 offset:16384
    v_mfma_f32_32x32x16_bf16 v[80:95], v[24:27], v[44:47], v[80:95]
    ds_read_b64_tr_b16 v[18:19], v4 offset:18432
    ds_read_b128 v[36:39], v6 offset:20480
    v_mfma_f32_32x32x16_bf16 v[96:111], v[28:31], v[40:43], v[96:111]
    ds_read_b64_tr_b16 v[20:21], v5 offset:16384
    ds_read_b64_tr_b16 v[22:23], v5 offset:18432
    v_mfma_f32_32x32x16_bf16 v[112:127], v[28:31], v[44:47], v[112:127]
    s_waitcnt lgkmcnt(3)
    v_mfma_f32_32x32x16_bf16 v[64:79], v[16:19], v[32:35], v[64:79]
    ds_read_b128 v[40:43], v6 offset:17408
    ds_read_b64_tr_b16 v[24:25], v4 offset:20480
    s_waitcnt lgkmcnt(4)
    v_mfma_f32_32x32x16_bf16 v[80:95], v[16:19], v[36:39], v[80:95]
    ds_read_b64_tr_b16 v[26:27], v4 offset:22528
    ds_read_b128 v[44:47], v6 offset:21504
    s_waitcnt lgkmcnt(4)
    v_mfma_f32_32x32x16_bf16 v[96:111], v[20:23], v[32:35], v[96:111]
    ds_read_b64_tr_b16 v[28:29], v5 offset:20480
    ds_read_b64_tr_b16 v[30:31], v5 offset:22528
    v_mfma_f32_32x32x16_bf16 v[112:127], v[20:23], v[36:39], v[112:127]
    s_waitcnt lgkmcnt(3)
    v_mfma_f32_32x32x16_bf16 v[64:79], v[24:27], v[40:43], v[64:79]
    ds_read_b128 v[32:35], v6 offset:18432
    ds_read_b64_tr_b16 v[16:17], v4 offset:24576
    s_waitcnt lgkmcnt(4)
    v_mfma_f32_32x32x16_bf16 v[80:95], v[24:27], v[44:47], v[80:95]
    ds_read_b64_tr_b16 v[18:19], v4 offset:26624
    ds_read_b128 v[36:39], v6 offset:22528
    s_waitcnt lgkmcnt(4)
    v_mfma_f32_32x32x16_bf16 v[96:111], v[28:31], v[40:43], v[96:111]
    ds_read_b64_tr_b16 v[20:21], v5 offset:24576
    ds_read_b64_tr_b16 v[22:23], v5 offset:26624
    v_mfma_f32_32x32x16_bf16 v[112:127], v[28:31], v[44:47], v[112:127]
    s_waitcnt lgkmcnt(3)
    v_mfma_f32_32x32x16_bf16 v[64:79], v[16:19], v[32:35], v[64:79]
    ds_read_b128 v[40:43], v6 offset:19456
    ds_read_b64_tr_b16 v[24:25], v4 offset:28672
    s_waitcnt lgkmcnt(4)
    v_mfma_f32_32x32x16_bf16 v[80:95], v[16:19], v[36:39], v[80:95]
    ds_read_b64_tr_b16 v[26:27], v4 offset:30720
    ds_read_b128 v[44:47], v6 offset:23552
    s_waitcnt lgkmcnt(4)
    v_mfma_f32_32x32x16_bf16 v[96:111], v[20:23], v[32:35], v[96:111]
    ds_read_b64_tr_b16 v[28:29], v5 offset:28672
    ds_read_b64_tr_b16 v[30:31], v5 offset:30720
    v_mfma_f32_32x32x16_bf16 v[112:127], v[20:23], v[36:39], v[112:127]
    s_waitcnt lgkmcnt(0)
    s_barrier
    v_mfma_f32_32x32x16_bf16 v[64:79], v[24:27], v[40:43], v[64:79]
    ds_read_b128 v[32:35], v6 offset:32768
    ds_read_b64_tr_b16 v[16:17], v2
    v_mfma_f32_32x32x16_bf16 v[80:95], v[24:27], v[44:47], v[80:95]
    ds_read_b64_tr_b16 v[18:19], v2 offset:2048
    ds_read_b128 v[36:39], v6 offset:36864
    v_mfma_f32_32x32x16_bf16 v[96:111], v[28:31], v[40:43], v[96:111]
    ds_read_b64_tr_b16 v[20:21], v3
    ds_read_b64_tr_b16 v[22:23], v3 offset:2048
    v_mfma_f32_32x32x16_bf16 v[112:127], v[28:31], v[44:47], v[112:127]
    s_waitcnt lgkmcnt(3)
    v_mfma_f32_32x32x16_bf16 v[64:79], v[16:19], v[32:35], v[64:79]
    ds_read_b128 v[40:43], v6 offset:33792
    ds_read_b64_tr_b16 v[24:25], v2 offset:4096
    s_waitcnt lgkmcnt(4)
    v_mfma_f32_32x32x16_bf16 v[80:95], v[16:19], v[36:39], v[80:95]
    ds_read_b64_tr_b16 v[26:27], v2 offset:6144
    ds_read_b128 v[44:47], v6 offset:37888
    s_waitcnt lgkmcnt(4)
    v_mfma_f32_32x32x16_bf16 v[96:111], v[20:23], v[32:35], v[96:111]
    ds_read_b64_tr_b16 v[28:29], v3 offset:4096
    ds_read_b64_tr_b16 v[30:31], v3 offset:6144
    v_mfma_f32_32x32x16_bf16 v[112:127], v[20:23], v[36:39], v[112:127]
    s_waitcnt lgkmcnt(3)
    v_mfma_f32_32x32x16_bf16 v[64:79], v[24:27], v[40:43], v[64:79]
    ds_read_b128 v[32:35], v6 offset:34816
    ds_read_b64_tr_b16 v[16:17], v2 offset:8192
    s_waitcnt lgkmcnt(4)
    v_mfma_f32_32x32x16_bf16 v[80:95], v[24:27], v[44:47], v[80:95]
    ds_read_b64_tr_b16 v[18:19], v2 offset:10240
    ds_read_b128 v[36:39], v6 offset:38912
    s_waitcnt lgkmcnt(4)
    v_mfma_f32_32x32x16_bf16 v[96:111], v[28:31], v[40:43], v[96:111]
    ds_read_b64_tr_b16 v[20:21], v3 offset:8192
    ds_read_b64_tr_b16 v[22:23], v3 offset:10240
    v_mfma_f32_32x32x16_bf16 v[112:127], v[28:31], v[44:47], v[112:127]
    s_waitcnt lgkmcnt(3)
    v_mfma_f32_32x32x16_bf16 v[64:79], v[16:19], v[32:35], v[64:79]
    ds_read_b128 v[40:43], v6 offset:35840
    ds_read_b64_tr_b16 v[24:25], v2 offset:12288
    s_waitcnt lgkmcnt(4)
    v_mfma_f32_32x32x16_bf16 v[80:95], v[16:19], v[36:39], v[80:95]
    ds_read_b64_tr_b16 v[26:27], v2 offset:14336
    ds_read_b128 v[44:47], v6 offset:39936
    s_waitcnt lgkmcnt(4)
    v_mfma_f32_32x32x16_bf16 v[96:111], v[20:23], v[32:35], v[96:111]
    ds_read_b64_tr_b16 v[28:29], v3 offset:12288
    ds_read_b64_tr_b16 v[30:31], v3 offset:14336
    v_mfma_f32_32x32x16_bf16 v[112:127], v[20:23], v[36:39], v[112:127]
    s_waitcnt lgkmcnt(0)
    s_barrier
    v_mfma_f32_32x32x16_bf16 v[64:79], v[24:27], v[40:43], v[64:79]
    ds_read_b128 v[32:35], v6 offset:49152
    ds_read_b64_tr_b16 v[16:17], v2 offset:16384
    v_mfma_f32_32x32x16_bf16 v[80:95], v[24:27], v[44:47], v[80:95]
    ds_read_b64_tr_b16 v[18:19], v2 offset:18432
    ds_read_b128 v[36:39], v6 offset:53248
    v_mfma_f32_32x32x16_bf16 v[96:111], v[28:31], v[40:43], v[96:111]
    ds_read_b64_tr_b16 v[20:21], v3 offset:16384
    ds_read_b64_tr_b16 v[22:23], v3 offset:18432
    v_mfma_f32_32x32x16_bf16 v[112:127], v[28:31], v[44:47], v[112:127]
    s_waitcnt lgkmcnt(3)
    v_mfma_f32_32x32x16_bf16 v[64:79], v[16:19], v[32:35], v[64:79]
    ds_read_b128 v[40:43], v6 offset:50176
    ds_read_b64_tr_b16 v[24:25], v2 offset:20480
    s_waitcnt lgkmcnt(4)
    v_mfma_f32_32x32x16_bf16 v[80:95], v[16:19], v[36:39], v[80:95]
    ds_read_b64_tr_b16 v[26:27], v2 offset:22528
    ds_read_b128 v[44:47], v6 offset:54272
    s_waitcnt lgkmcnt(4)
    v_mfma_f32_32x32x16_bf16 v[96:111], v[20:23], v[32:35], v[96:111]
    ds_read_b64_tr_b16 v[28:29], v3 offset:20480
    ds_read_b64_tr_b16 v[30:31], v3 offset:22528
    v_mfma_f32_32x32x16_bf16 v[112:127], v[20:23], v[36:39], v[112:127]
    s_waitcnt lgkmcnt(3)
    v_mfma_f32_32x32x16_bf16 v[64:79], v[24:27], v[40:43], v[64:79]
    ds_read_b128 v[32:35], v6 offset:51200
    ds_read_b64_tr_b16 v[16:17], v2 offset:24576
    s_waitcnt lgkmcnt(4)
    v_mfma_f32_32x32x16_bf16 v[80:95], v[24:27], v[44:47], v[80:95]
    ds_read_b64_tr_b16 v[18:19], v2 offset:26624
    ds_read_b128 v[36:39], v6 offset:55296
    s_waitcnt lgkmcnt(4)
    v_mfma_f32_32x32x16_bf16 v[96:111], v[28:31], v[40:43], v[96:111]
    ds_read_b64_tr_b16 v[20:21], v3 offset:24576
    ds_read_b64_tr_b16 v[22:23], v3 offset:26624
    v_mfma_f32_32x32x16_bf16 v[112:127], v[28:31], v[44:47], v[112:127]
    s_waitcnt lgkmcnt(3)
    v_mfma_f32_32x32x16_bf16 v[64:79], v[16:19], v[32:35], v[64:79]
    ds_read_b128 v[40:43], v6 offset:52224
    ds_read_b64_tr_b16 v[24:25], v2 offset:28672
    s_waitcnt lgkmcnt(4)
    v_mfma_f32_32x32x16_bf16 v[80:95], v[16:19], v[36:39], v[80:95]
    ds_read_b64_tr_b16 v[26:27], v2 offset:30720
    ds_read_b128 v[44:47], v6 offset:56320
    s_waitcnt lgkmcnt(4)
    v_mfma_f32_32x32x16_bf16 v[96:111], v[20:23], v[32:35], v[96:111]
    ds_read_b64_tr_b16 v[28:29], v3 offset:28672
    ds_read_b64_tr_b16 v[30:31], v3 offset:30720
    v_mfma_f32_32x32x16_bf16 v[112:127], v[20:23], v[36:39], v[112:127]
    s_waitcnt lgkmcnt(0)
    s_barrier
    v_mfma_f32_32x32x16_bf16 v[64:79], v[24:27], v[40:43], v[64:79]
    v_mfma_f32_32x32x16_bf16 v[80:95], v[24:27], v[44:47], v[80:95]
    v_mfma_f32_32x32x16_bf16 v[96:111], v[28:31], v[40:43], v[96:111]
    v_mfma_f32_32x32x16_bf16 v[112:127], v[28:31], v[44:47], v[112:127]
    v_mov_b32 v10, 131072
    ds_read_b64 v[8:9], v10 offset:8
    v_lshlrev_b32 v11, 4, v1
    s_lshl_b32 s44, s80, 2
    s_add_u32 s44, s44, s43
    s_lshl_b32 s44, s44, 12
    s_waitcnt lgkmcnt(0)
    s_cmp_eq_u32 s80, 0
    s_cbranch_scc1 P2_OWN0
    s_add_u32 s45, s44, 0
    s_nop 7
    v_cvt_pk_bf16_f32 v128, v64, v65
    v_cvt_pk_bf16_f32 v129, v66, v67
    v_cvt_pk_bf16_f32 v130, v68, v69
    v_cvt_pk_bf16_f32 v132, v70, v71
    v_cvt_pk_bf16_f32 v133, v72, v73
    v_cvt_pk_bf16_f32 v134, v74, v75
    v_cvt_pk_bf16_f32 v136, v76, v77
    v_cvt_pk_bf16_f32 v137, v78, v79
    v_mov_b32 v131, v8
    v_mov_b32 v135, v8
    v_mov_b32 v138, v8
    v_mov_b32 v139, v8
    buffer_store_dwordx4 v[128:131], v11, s[56:59], s45 offen sc1
    buffer_store_dwordx4 v[132:135], v11, s[56:59], s45 offen offset:1024 sc1
    buffer_store_dwordx4 v[136:139], v11, s[56:59], s45 offen offset:2048 sc1
    s_branch P2_N0
P2_OWN0:
    s_nop 15
    v_mov_b32 v48, v64
    v_mov_b32 v49, v65
    v_mov_b32 v50, v66
    v_mov_b32 v51, v67
    v_mov_b32 v52, v68
    v_mov_b32 v53, v69
    v_mov_b32 v54, v70
    v_mov_b32 v55, v71
    v_mov_b32 v56, v72
    v_mov_b32 v57, v73
    v_mov_b32 v58, v74
    v_mov_b32 v59, v75
    v_mov_b32 v60, v76
    v_mov_b32 v61, v77
    v_mov_b32 v62, v78
    v_mov_b32 v63, v79
P2_N0:
    s_cmp_eq_u32 s80, 1
    s_cbranch_scc1 P2_OWN1
    s_add_u32 s45, s44, 65536
    s_nop 7
    v_cvt_pk_bf16_f32 v140, v80, v81
    v_cvt_pk_bf16_f32 v141, v82, v83
    v_cvt_pk_bf16_f32 v142, v84, v85
    v_cvt_pk_bf16_f32 v144, v86, v87
    v_cvt_pk_bf16_f32 v145, v88, v89
    v_cvt_pk_bf16_f32 v146, v90, v91
    v_cvt_pk_bf16_f32 v148, v92, v93
    v_cvt_pk_bf16_f32 v149, v94, v95
    v_mov_b32 v143, v8
    v_mov_b32 v147, v8
    v_mov_b32 v150, v8
    v_mov_b32 v151, v8
    buffer_store_dwordx4 v[140:143], v11, s[56:59], s45 offen sc1
    buffer_store_dwordx4 v[144:147], v11, s[56:59], s45 offen offset:1024 sc1
    buffer_store_dwordx4 v[148:151], v11, s[56:59], s45 offen offset:2048 sc1
    s_branch P2_N1
P2_OWN1:
    s_nop 15
    v_mov_b32 v48, v80
    v_mov_b32 v49, v81
    v_mov_b32 v50, v82
    v_mov_b32 v51, v83
    v_mov_b32 v52, v84
    v_mov_b32 v53, v85
    v_mov_b32 v54, v86
    v_mov_b32 v55, v87
    v_mov_b32 v56, v88
    v_mov_b32 v57, v89
    v_mov_b32 v58, v90
    v_mov_b32 v59, v91
    v_mov_b32 v60, v92
    v_mov_b32 v61, v93
    v_mov_b32 v62, v94
    v_mov_b32 v63, v95
P2_N1:
    s_cmp_eq_u32 s80, 2
    s_cbranch_scc1 P2_OWN2
    s_add_u32 s45, s44, 131072
    s_nop 7
    v_cvt_pk_bf16_f32 v152, v96, v97
    v_cvt_pk_bf16_f32 v153, v98, v99
    v_cvt_pk_bf16_f32 v154, v100, v101
    v_cvt_pk_bf16_f32 v156, v102, v103
    v_cvt_pk_bf16_f32 v157, v104, v105
    v_cvt_pk_bf16_f32 v158, v106, v107
    v_cvt_pk_bf16_f32 v160, v108, v109
    v_cvt_pk_bf16_f32 v161, v110, v111
    v_mov_b32 v155, v8
    v_mov_b32 v159, v8
    v_mov_b32 v162, v8
    v_mov_b32 v163, v8
    buffer_store_dwordx4 v[152:155], v11, s[56:59], s45 offen sc1
    buffer_store_dwordx4 v[156:159], v11, s[56:59], s45 offen offset:1024 sc1
    buffer_store_dwordx4 v[160:163], v11, s[56:59], s45 offen offset:2048 sc1
    s_branch P2_N2
P2_OWN2:
    s_nop 15
    v_mov_b32 v48, v96
    v_mov_b32 v49, v97
    v_mov_b32 v50, v98
    v_mov_b32 v51, v99
    v_mov_b32 v52, v100
    v_mov_b32 v53, v101
    v_mov_b32 v54, v102
    v_mov_b32 v55, v103
    v_mov_b32 v56, v104
    v_mov_b32 v57, v105
    v_mov_b32 v58, v106
    v_mov_b32 v59, v107
    v_mov_b32 v60, v108
    v_mov_b32 v61, v109
    v_mov_b32 v62, v110
    v_mov_b32 v63, v111
P2_N2:
    s_cmp_eq_u32 s80, 3
    s_cbranch_scc1 P2_OWN3
    s_add_u32 s45, s44, 196608
    s_nop 7
    v_cvt_pk_bf16_f32 v164, v112, v113
    v_cvt_pk_bf16_f32 v165, v114, v115
    v_cvt_pk_bf16_f32 v166, v116, v117
    v_cvt_pk_bf16_f32 v168, v118, v119
    v_cvt_pk_bf16_f32 v169, v120, v121
    v_cvt_pk_bf16_f32 v170, v122, v123
    v_cvt_pk_bf16_f32 v172, v124, v125
    v_cvt_pk_bf16_f32 v173, v126, v127
    v_mov_b32 v167, v8
    v_mov_b32 v171, v8
    v_mov_b32 v174, v8
    v_mov_b32 v175, v8
    buffer_store_dwordx4 v[164:167], v11, s[56:59], s45 offen sc1
    buffer_store_dwordx4 v[168:171], v11, s[56:59], s45 offen offset:1024 sc1
    buffer_store_dwordx4 v[172:175], v11, s[56:59], s45 offen offset:2048 sc1
    s_branch P2_N3
P2_OWN3:
    s_nop 15
    v_mov_b32 v48, v112
    v_mov_b32 v49, v113
    v_mov_b32 v50, v114
    v_mov_b32 v51, v115
    v_mov_b32 v52, v116
    v_mov_b32 v53, v117
    v_mov_b32 v54, v118
    v_mov_b32 v55, v119
    v_mov_b32 v56, v120
    v_mov_b32 v57, v121
    v_mov_b32 v58, v122
    v_mov_b32 v59, v123
    v_mov_b32 v60, v124
    v_mov_b32 v61, v125
    v_mov_b32 v62, v126
    v_mov_b32 v63, v127
P2_N3:
    s_add_u32 s45, s80, 1
    s_and_b32 s45, s45, 3
    s_lshl_b32 s46, s80, 2
    s_add_u32 s45, s45, s46
    s_lshl_b32 s45, s45, 2
    s_add_u32 s45, s45, s43
    s_lshl_b32 s88, s45, 12
    s_add_u32 s45, s80, 2
    s_and_b32 s45, s45, 3
    s_lshl_b32 s46, s80, 2
    s_add_u32 s45, s45, s46
    s_lshl_b32 s45, s45, 2
    s_add_u32 s45, s45, s43
    s_lshl_b32 s89, s45, 12
    s_add_u32 s45, s80, 3
    s_and_b32 s45, s45, 3
    s_lshl_b32 s46, s80, 2
    s_add_u32 s45, s45, s46
    s_lshl_b32 s45, s45, 2
    s_add_u32 s45, s45, s43
    s_lshl_b32 s90, s45, 12
    s_waitcnt vmcnt(0)
    s_mov_b32 s83, 0
    s_mov_b32 s94, 0
P2_XP:
    s_nop 4
    s_bitcmp1_b32 s94, 0
    s_cbranch_scc1 P2_XL0
    buffer_load_dwordx4 v[180:183], v11, s[56:59], s88 offen offset:0 sc1
    buffer_load_dwordx4 v[184:187], v11, s[56:59], s88 offen offset:1024 sc1
    buffer_load_dwordx4 v[188:191], v11, s[56:59], s88 offen offset:2048 sc1
P2_XL0:
    s_bitcmp1_b32 s94, 1
    s_cbranch_scc1 P2_XL1
    buffer_load_dwordx4 v[192:195], v11, s[56:59], s89 offen offset:0 sc1
    buffer_load_dwordx4 v[196:199], v11, s[56:59], s89 offen offset:1024 sc1
    buffer_load_dwordx4 v[200:203], v11, s[56:59], s89 offen offset:2048 sc1
P2_XL1:
    s_bitcmp1_b32 s94, 2
    s_cbranch_scc1 P2_XL2
    buffer_load_dwordx4 v[204:207], v11, s[56:59], s90 offen offset:0 sc1
    buffer_load_dwordx4 v[208:211], v11, s[56:59], s90 offen offset:1024 sc1
    buffer_load_dwordx4 v[212:215], v11, s[56:59], s90 offen offset:2048 sc1
P2_XL2:
    s_waitcnt vmcnt(0)
    s_bitcmp1_b32 s94, 0
    s_cbranch_scc1 P2_XC0
    v_cmp_eq_u32 vcc, v8, v183
    v_cmp_eq_u32 s[86:87], v8, v187
    v_cmp_eq_u32 s[92:93], v8, v191
    s_nop 4
    s_and_b64 vcc, vcc, s[86:87]
    s_and_b64 vcc, vcc, s[92:93]
    s_cmp_eq_u64 vcc, exec
    s_cbranch_scc0 P2_XC0
    s_bitset1_b32 s94, 0
P2_XC0:
    s_bitcmp1_b32 s94, 1
    s_cbranch_scc1 P2_XC1
    v_cmp_eq_u32 vcc, v8, v195
    v_cmp_eq_u32 s[86:87], v8, v199
    v_cmp_eq_u32 s[92:93], v8, v203
    s_nop 4
    s_and_b64 vcc, vcc, s[86:87]
    s_and_b64 vcc, vcc, s[92:93]
    s_cmp_eq_u64 vcc, exec
    s_cbranch_scc0 P2_XC1
    s_bitset1_b32 s94, 1
P2_XC1:
    s_bitcmp1_b32 s94, 2
    s_cbranch_scc1 P2_XC2
    v_cmp_eq_u32 vcc, v8, v207
    v_cmp_eq_u32 s[86:87], v8, v211
    v_cmp_eq_u32 s[92:93], v8, v215
    s_nop 4
    s_and_b64 vcc, vcc, s[86:87]
    s_and_b64 vcc, vcc, s[92:93]
    s_cmp_eq_u64 vcc, exec
    s_cbranch_scc0 P2_XC2
    s_bitset1_b32 s94, 2
P2_XC2:
    s_cmp_eq_u32 s94, 7
    s_cbranch_scc1 P2_XDONE
    s_add_u32 s83, s83, 1
    s_cmp_gt_u32 s83, 200000
    s_cbranch_scc1 P2_XDONE
    s_sleep 2
    s_branch P2_XP
P2_XDONE:
    s_branch P2_TQ_OK
    s_mov_b32 s83, 0
P2_TP:
    s_nop 4
    buffer_load_dwordx4 v[188:191], v11, s[56:59], s88 offen offset:2048 sc1
    buffer_load_dwordx4 v[200:203], v11, s[56:59], s89 offen offset:2048 sc1
    buffer_load_dwordx4 v[212:215], v11, s[56:59], s90 offen offset:2048 sc1
    s_waitcnt vmcnt(0)
    v_cmp_eq_u32 vcc, v8, v191
    v_cmp_eq_u32 s[86:87], v8, v203
    v_cmp_eq_u32 s[92:93], v8, v215
    s_nop 4
    s_and_b64 vcc, vcc, s[86:87]
    s_and_b64 vcc, vcc, s[92:93]
    s_cmp_eq_u64 vcc, exec
    s_cbranch_scc1 P2_TP_OK
    s_add_u32 s83, s83, 1
    s_cmp_gt_u32 s83, 200000
    s_cbranch_scc1 P2_TP_OK
    s_sleep 2
    s_branch P2_TP
P2_TP_OK:
    s_mov_b32 s83, 0
P2_TQ:
    s_nop 4
    buffer_load_dwordx4 v[180:183], v11, s[56:59], s88 offen offset:0 sc1
    buffer_load_dwordx4 v[184:187], v11, s[56:59], s88 offen offset:1024 sc1
    buffer_load_dwordx4 v[192:195], v11, s[56:59], s89 offen offset:0 sc1
    buffer_load_dwordx4 v[196:199], v11, s[56:59], s89 offen offset:1024 sc1
    buffer_load_dwordx4 v[204:207], v11, s[56:59], s90 offen offset:0 sc1
    buffer_load_dwordx4 v[208:211], v11, s[56:59], s90 offen offset:1024 sc1
    s_waitcnt vmcnt(0)
    s_mov_b64 s[94:95], exec
    v_cmp_eq_u32 vcc, v8, v183
    s_nop 4
    s_and_b64 s[94:95], s[94:95], vcc
    v_cmp_eq_u32 vcc, v8, v187
    s_nop 4
    s_and_b64 s[94:95], s[94:95], vcc
    v_cmp_eq_u32 vcc, v8, v195
    s_nop 4
    s_and_b64 s[94:95], s[94:95], vcc
    v_cmp_eq_u32 vcc, v8, v199
    s_nop 4
    s_and_b64 s[94:95], s[94:95], vcc
    v_cmp_eq_u32 vcc, v8, v207
    s_nop 4
    s_and_b64 s[94:95], s[94:95], vcc
    v_cmp_eq_u32 vcc, v8, v211
    s_nop 4
    s_and_b64 s[94:95], s[94:95], vcc
    s_cmp_eq_u64 s[94:95], exec
    s_cbranch_scc1 P2_TQ_OK
    s_add_u32 s83, s83, 1
    s_cmp_gt_u32 s83, 200000
    s_cbranch_scc1 P2_TQ_OK
    s_sleep 1
    s_branch P2_TQ
P2_TQ_OK:
    s_mov_b32 s46, 0xffff0000
    v_lshlrev_b32 v16, 16, v180
    v_and_b32 v17, s46, v180
    v_add_f32 v48, v48, v16
    v_add_f32 v49, v49, v17
    v_lshlrev_b32 v16, 16, v181
    v_and_b32 v17, s46, v181
    v_add_f32 v50, v50, v16
    v_add_f32 v51, v51, v17
    v_lshlrev_b32 v16, 16, v182
    v_and_b32 v17, s46, v182
    v_add_f32 v52, v52, v16
    v_add_f32 v53, v53, v17
    v_lshlrev_b32 v16, 16, v184
    v_and_b32 v17, s46, v184
    v_add_f32 v54, v54, v16
    v_add_f32 v55, v55, v17
    v_lshlrev_b32 v16, 16, v185
    v_and_b32 v17, s46, v185
    v_add_f32 v56, v56, v16
    v_add_f32 v57, v57, v17
    v_lshlrev_b32 v16, 16, v186
    v_and_b32 v17, s46, v186
    v_add_f32 v58, v58, v16
    v_add_f32 v59, v59, v17
    v_lshlrev_b32 v16, 16, v188
    v_and_b32 v17, s46, v188
    v_add_f32 v60, v60, v16
    v_add_f32 v61, v61, v17
    v_lshlrev_b32 v16, 16, v189
    v_and_b32 v17, s46, v189
    v_add_f32 v62, v62, v16
    v_add_f32 v63, v63, v17
    v_lshlrev_b32 v16, 16, v192
    v_and_b32 v17, s46, v192
    v_add_f32 v48, v48, v16
    v_add_f32 v49, v49, v17
    v_lshlrev_b32 v16, 16, v193
    v_and_b32 v17, s46, v193
    v_add_f32 v50, v50, v16
    v_add_f32 v51, v51, v17
    v_lshlrev_b32 v16, 16, v194
    v_and_b32 v17, s46, v194
    v_add_f32 v52, v52, v16
    v_add_f32 v53, v53, v17
    v_lshlrev_b32 v16, 16, v196
    v_and_b32 v17, s46, v196
    v_add_f32 v54, v54, v16
    v_add_f32 v55, v55, v17
    v_lshlrev_b32 v16, 16, v197
    v_and_b32 v17, s46, v197
    v_add_f32 v56, v56, v16
    v_add_f32 v57, v57, v17
    v_lshlrev_b32 v16, 16, v198
    v_and_b32 v17, s46, v198
    v_add_f32 v58, v58, v16
    v_add_f32 v59, v59, v17
    v_lshlrev_b32 v16, 16, v200
    v_and_b32 v17, s46, v200
    v_add_f32 v60, v60, v16
    v_add_f32 v61, v61, v17
    v_lshlrev_b32 v16, 16, v201
    v_and_b32 v17, s46, v201
    v_add_f32 v62, v62, v16
    v_add_f32 v63, v63, v17
    v_lshlrev_b32 v16, 16, v204
    v_and_b32 v17, s46, v204
    v_add_f32 v48, v48, v16
    v_add_f32 v49, v49, v17
    v_lshlrev_b32 v16, 16, v205
    v_and_b32 v17, s46, v205
    v_add_f32 v50, v50, v16
    v_add_f32 v51, v51, v17
    v_lshlrev_b32 v16, 16, v206
    v_and_b32 v17, s46, v206
    v_add_f32 v52, v52, v16
    v_add_f32 v53, v53, v17
    v_lshlrev_b32 v16, 16, v208
    v_and_b32 v17, s46, v208
    v_add_f32 v54, v54, v16
    v_add_f32 v55, v55, v17
    v_lshlrev_b32 v16, 16, v209
    v_and_b32 v17, s46, v209
    v_add_f32 v56, v56, v16
    v_add_f32 v57, v57, v17
    v_lshlrev_b32 v16, 16, v210
    v_and_b32 v17, s46, v210
    v_add_f32 v58, v58, v16
    v_add_f32 v59, v59, v17
    v_lshlrev_b32 v16, 16, v212
    v_and_b32 v17, s46, v212
    v_add_f32 v60, v60, v16
    v_add_f32 v61, v61, v17
    v_lshlrev_b32 v16, 16, v213
    v_and_b32 v17, s46, v213
    v_add_f32 v62, v62, v16
    v_add_f32 v63, v63, v17
    v_cvt_pk_bf16_f32 v16, v48, v49
    v_cvt_pk_bf16_f32 v17, v50, v51
    v_cvt_pk_bf16_f32 v18, v52, v53
    v_cvt_pk_bf16_f32 v19, v54, v55
    v_cvt_pk_bf16_f32 v20, v56, v57
    v_cvt_pk_bf16_f32 v21, v58, v59
    v_cvt_pk_bf16_f32 v22, v60, v61
    v_cvt_pk_bf16_f32 v23, v62, v63
    v_and_b32 v10, 31, v1
    v_lshlrev_b32 v10, 11, v10
    v_lshrrev_b32 v12, 5, v1
    v_lshlrev_b32 v12, 4, v12
    v_add_u32 v10, v10, v12
    s_and_b32 s44, s43, 1
    s_lshl_b32 s44, s44, 1
    s_and_b32 s45, s80, 1
    s_add_u32 s44, s44, s45
    s_lshl_b32 s44, s44, 16
    s_lshr_b32 s45, s43, 1
    s_lshl_b32 s45, s45, 7
    s_add_u32 s44, s44, s45
    s_lshr_b32 s45, s80, 1
    s_lshl_b32 s45, s45, 6
    s_add_u32 s44, s44, s45
    buffer_store_dwordx4 v[16:19], v10, s[64:67], s44 offen
    buffer_store_dwordx4 v[20:23], v10, s[64:67], s44 offen offset:32
    s_endpgm
K1_FAST:
    s_sub_u32 s44, s43, 4
    v_lshrrev_b32 v2, 5, v1
    v_and_b32 v3, 31, v1
    v_lshlrev_b32 v4, 2, v2
    v_xor_b32 v10, v3, v4
    v_lshlrev_b32 v10, 4, v10
    v_xor_b32 v11, 128, v10
    v_lshlrev_b32 v4, 13, v2
    s_lshl_b32 s45, s44, 16
    v_add_u32 v4, s45, v4
    v_add_u32 v10, v10, v4
    v_add_u32 v11, v11, v4
    v_lshrrev_b32 v2, 3, v1
    v_and_b32 v3, 7, v1
    v_lshrrev_b32 v4, 4, v1
    v_xor_b32 v12, v3, v4
    v_lshlrev_b32 v12, 4, v12
    v_xor_b32 v13, 64, v12
    v_lshlrev_b32 v2, 10, v2
    s_lshl_b32 s45, s44, 15
    v_add_u32 v2, s45, v2
    v_add_u32 v12, v12, v2
    v_add_u32 v13, v13, v2
    s_lshl_b32 s47, s44, 12
    s_and_b32 s79, s41, 3
    s_lshl_b32 s79, s79, 1
    s_and_b32 s45, s42, 1
    s_add_u32 s79, s79, s45
    s_and_b32 s79, s79, 7
    s_cmp_eq_u32 s40, 0
    s_waitcnt lgkmcnt(0)
    s_cselect_b64 s[16:17], s[16:17], s[26:27]
    s_cselect_b64 s[22:23], s[22:23], s[32:33]
    s_cselect_b64 s[18:19], s[18:19], s[28:29]
    s_cselect_b64 s[20:21], s[20:21], s[30:31]
    s_cselect_b64 s[24:25], s[24:25], s[34:35]
    s_lshl_b32 s44, s41, 9
    s_add_u32 s48, s22, s44
    s_addc_u32 s49, s23, 0
    s_sub_u32 s50, 4194304, s44
    s_mov_b32 s51, 0x20000
    s_lshl_b32 s44, s42, 17
    s_add_u32 s52, s16, s44
    s_addc_u32 s53, s17, 0
    s_sub_u32 s54, 1048576, s44
    s_mov_b32 s55, 0x20000
    s_add_u32 s13, s79, 0
    s_and_b32 s13, s13, 7
    s_lshl_b32 s13, s13, 19
    s_add_u32 m0, s47, 65536
    s_add_u32 s46, s13, 0
    buffer_load_dwordx4 v10, s[48:51], s46 offen lds
    s_add_u32 m0, s47, 66560
    s_add_u32 s46, s13, 16384
    buffer_load_dwordx4 v11, s[48:51], s46 offen lds
    s_add_u32 m0, s47, 67584
    s_add_u32 s46, s13, 32768
    buffer_load_dwordx4 v10, s[48:51], s46 offen lds
    s_add_u32 m0, s47, 68608
    s_add_u32 s46, s13, 49152
    buffer_load_dwordx4 v11, s[48:51], s46 offen lds
    s_add_u32 s13, s79, 0
    s_and_b32 s13, s13, 7
    s_lshl_b32 s13, s13, 7
    s_add_u32 m0, s47, 131072
    s_add_u32 s46, s13, 0
    buffer_load_dwordx4 v12, s[52:55], s46 offen lds
    s_add_u32 m0, s47, 132096
    s_add_u32 s46, s13, 8192
    buffer_load_dwordx4 v13, s[52:55], s46 offen lds
    s_add_u32 m0, s47, 133120
    s_add_u32 s46, s13, 16384
    buffer_load_dwordx4 v12, s[52:55], s46 offen lds
    s_add_u32 m0, s47, 134144
    s_add_u32 s46, s13, 24576
    buffer_load_dwordx4 v13, s[52:55], s46 offen lds
    s_lshl_b32 s44, s42, 20
    s_lshl_b32 s45, s41, 14
    s_add_u32 s44, s44, s45
    s_add_u32 s56, s18, s44
    s_addc_u32 s57, s19, 0
    s_sub_u32 s58, 8388608, s44
    s_mov_b32 s59, 0x20000
    s_add_u32 s60, s20, s44
    s_addc_u32 s61, s21, 0
    s_sub_u32 s62, 8388608, s44
    s_mov_b32 s63, 0x20000
    s_lshl_b32 s45, s40, 23
    s_add_u32 s44, s44, s45
    s_add_u32 s64, s38, s44
    s_addc_u32 s65, s39, 0
    s_sub_u32 s66, 16777216, s44
    s_mov_b32 s67, 0x20000
    s_cmp_lg_u32 s43, 4
    s_cbranch_scc1 L_NOTLB
    v_mov_b32 v26, 0
    s_mov_b64 s[86:87], exec
    s_mov_b64 exec, 1
    s_add_u32 s92, s56, 0
    s_addc_u32 s93, s57, 0
    global_load_dword v27, v26, s[92:93]
    s_add_u32 s92, s60, 0
    s_addc_u32 s93, s61, 0
    global_load_dword v27, v26, s[92:93]
    s_add_u32 s92, s64, 0
    s_addc_u32 s93, s65, 0
    global_load_dword v27, v26, s[92:93]
    s_lshr_b32 s45, s41, 2
    s_lshl_b32 s45, s45, 20
    s_add_u32 s92, s24, s45
    s_addc_u32 s93, s25, 0
    global_load_dword v27, v26, s[92:93]
    s_lshl_b32 s45, s40, 3
    s_add_u32 s45, s45, s42
    s_lshl_b32 s45, s45, 2
    s_and_b32 s46, s41, 3
    s_add_u32 s45, s45, s46
    s_lshl_b32 s45, s45, 18
    s_add_u32 s45, s45, 33554432
    s_add_u32 s92, s38, s45
    s_addc_u32 s93, s39, 0
    global_load_dword v27, v26, s[92:93]
    s_add_u32 s92, s38, 58720256
    s_addc_u32 s93, s39, 0
    global_load_dword v27, v26, s[92:93]
    s_lshl_b32 s45, s42, 18
    s_add_u32 s92, s36, s45
    s_addc_u32 s93, s37, 0
    global_load_dword v27, v26, s[92:93]
    s_mov_b64 exec, s[86:87]
L_NOTLB:
    s_sub_u32 s44, s43, 4
    v_lshrrev_b32 v4, 4, v1
    v_and_b32 v3, 15, v1
    v_lshlrev_b32 v2, 8, v4
    s_and_b32 s45, s44, 1
    s_lshl_b32 s45, s45, 12
    s_lshr_b32 s46, s44, 1
    s_lshl_b32 s46, s46, 18
    s_add_u32 s45, s45, s46
    v_add_u32 v2, s45, v2
    v_xor_b32 v5, v3, v4
    v_xor_b32 v14, 0, v5
    v_lshlrev_b32 v14, 4, v14
    v_add_u32 v14, v14, v2
    v_xor_b32 v15, 4, v5
    v_lshlrev_b32 v15, 4, v15
    v_add_u32 v15, v15, v2
    v_add_u32 v15, 1024, v15
    v_xor_b32 v16, 8, v5
    v_lshlrev_b32 v16, 4, v16
    v_add_u32 v16, v16, v2
    v_add_u32 v16, 2048, v16
    v_xor_b32 v17, 12, v5
    v_lshlrev_b32 v17, 4, v17
    v_add_u32 v17, v17, v2
    v_add_u32 v17, 3072, v17
    v_lshlrev_b32 v5, 2, v4
    v_xor_b32 v18, v3, v5
    v_lshlrev_b32 v18, 4, v18
    v_add_u32 v18, v18, v2
    s_mov_b32 s14, 0
    v_lshlrev_b32 v19, 4, v1
    v_add_u32 v19, s47, v19
    v_add_u32 v20, 65536, v19
    v_add_u32 v21, 131072, v19
K1_PH0:
    s_add_u32 s13, s79, 0
    s_and_b32 s13, s13, 7
    s_lshl_b32 s13, s13, 19
    s_add_u32 m0, s47, 81920
    s_add_u32 s46, s13, 262144
    buffer_load_dwordx4 v10, s[48:51], s46 offen lds
    s_add_u32 m0, s47, 82944
    s_add_u32 s46, s13, 278528
    buffer_load_dwordx4 v11, s[48:51], s46 offen lds
    s_add_u32 m0, s47, 83968
    s_add_u32 s46, s13, 294912
    buffer_load_dwordx4 v10, s[48:51], s46 offen lds
    s_add_u32 m0, s47, 84992
    s_add_u32 s46, s13, 311296
    buffer_load_dwordx4 v11, s[48:51], s46 offen lds
    s_waitcnt vmcnt(8)
    s_waitcnt vmcnt(4)
    s_barrier
    s_add_u32 s13, s79, 1
    s_and_b32 s13, s13, 7
    s_lshl_b32 s13, s13, 19
    s_add_u32 m0, s47, 98304
    s_add_u32 s46, s13, 0
    buffer_load_dwordx4 v10, s[48:51], s46 offen lds
    s_add_u32 m0, s47, 99328
    s_add_u32 s46, s13, 16384
    buffer_load_dwordx4 v11, s[48:51], s46 offen lds
    s_add_u32 m0, s47, 100352
    s_add_u32 s46, s13, 32768
    buffer_load_dwordx4 v10, s[48:51], s46 offen lds
    s_add_u32 m0, s47, 101376
    s_add_u32 s46, s13, 49152
    buffer_load_dwordx4 v11, s[48:51], s46 offen lds
    s_add_u32 s13, s79, 1
    s_and_b32 s13, s13, 7
    s_lshl_b32 s13, s13, 7
    s_add_u32 m0, s47, 147456
    s_add_u32 s46, s13, 0
    buffer_load_dwordx4 v12, s[52:55], s46 offen lds
    s_add_u32 m0, s47, 148480
    s_add_u32 s46, s13, 8192
    buffer_load_dwordx4 v13, s[52:55], s46 offen lds
    s_add_u32 m0, s47, 149504
    s_add_u32 s46, s13, 16384
    buffer_load_dwordx4 v12, s[52:55], s46 offen lds
    s_add_u32 m0, s47, 150528
    s_add_u32 s46, s13, 24576
    buffer_load_dwordx4 v13, s[52:55], s46 offen lds
    s_add_u32 s13, s79, 1
    s_and_b32 s13, s13, 7
    s_lshl_b32 s13, s13, 19
    s_add_u32 m0, s47, 114688
    s_add_u32 s46, s13, 262144
    buffer_load_dwordx4 v10, s[48:51], s46 offen lds
    s_add_u32 m0, s47, 115712
    s_add_u32 s46, s13, 278528
    buffer_load_dwordx4 v11, s[48:51], s46 offen lds
    s_add_u32 m0, s47, 116736
    s_add_u32 s46, s13, 294912
    buffer_load_dwordx4 v10, s[48:51], s46 offen lds
    s_add_u32 m0, s47, 117760
    s_add_u32 s46, s13, 311296
    buffer_load_dwordx4 v11, s[48:51], s46 offen lds
    s_waitcnt vmcnt(12)
    s_barrier
    s_add_u32 s13, s79, 2
    s_and_b32 s13, s13, 7
    s_lshl_b32 s13, s13, 19
    s_add_u32 m0, s47, 65536
    s_add_u32 s46, s13, 0
    buffer_load_dwordx4 v10, s[48:51], s46 offen lds
    s_add_u32 m0, s47, 66560
    s_add_u32 s46, s13, 16384
    buffer_load_dwordx4 v11, s[48:51], s46 offen lds
    s_add_u32 m0, s47, 67584
    s_add_u32 s46, s13, 32768
    buffer_load_dwordx4 v10, s[48:51], s46 offen lds
    s_add_u32 m0, s47, 68608
    s_add_u32 s46, s13, 49152
    buffer_load_dwordx4 v11, s[48:51], s46 offen lds
    s_add_u32 m0, s47, 0
    s_add_u32 s46, s14, 0
    buffer_load_dwordx4 v14, s[56:59], s46 offen lds
    s_add_u32 m0, s47, 1024
    s_add_u32 s46, s14, 0
    buffer_load_dwordx4 v15, s[56:59], s46 offen lds
    s_add_u32 m0, s47, 2048
    s_add_u32 s46, s14, 0
    buffer_load_dwordx4 v16, s[56:59], s46 offen lds
    s_add_u32 m0, s47, 3072
    s_add_u32 s46, s14, 0
    buffer_load_dwordx4 v17, s[56:59], s46 offen lds
    s_waitcnt vmcnt(16)
    s_waitcnt vmcnt(12)
    s_barrier
    s_add_u32 s13, s79, 2
    s_and_b32 s13, s13, 7
    s_lshl_b32 s13, s13, 19
    s_add_u32 m0, s47, 81920
    s_add_u32 s46, s13, 262144
    buffer_load_dwordx4 v10, s[48:51], s46 offen lds
    s_add_u32 m0, s47, 82944
    s_add_u32 s46, s13, 278528
    buffer_load_dwordx4 v11, s[48:51], s46 offen lds
    s_add_u32 m0, s47, 83968
    s_add_u32 s46, s13, 294912
    buffer_load_dwordx4 v10, s[48:51], s46 offen lds
    s_add_u32 m0, s47, 84992
    s_add_u32 s46, s13, 311296
    buffer_load_dwordx4 v11, s[48:51], s46 offen lds
    s_add_u32 s13, s79, 2
    s_and_b32 s13, s13, 7
    s_lshl_b32 s13, s13, 7
    s_add_u32 m0, s47, 131072
    s_add_u32 s46, s13, 0
    buffer_load_dwordx4 v12, s[52:55], s46 offen lds
    s_add_u32 m0, s47, 132096
    s_add_u32 s46, s13, 8192
    buffer_load_dwordx4 v13, s[52:55], s46 offen lds
    s_add_u32 m0, s47, 133120
    s_add_u32 s46, s13, 16384
    buffer_load_dwordx4 v12, s[52:55], s46 offen lds
    s_add_u32 m0, s47, 134144
    s_add_u32 s46, s13, 24576
    buffer_load_dwordx4 v13, s[52:55], s46 offen lds
    s_add_u32 m0, s47, 16384
    s_add_u32 s46, s14, 524288
    buffer_load_dwordx4 v14, s[56:59], s46 offen lds
    s_add_u32 m0, s47, 17408
    s_add_u32 s46, s14, 524288
    buffer_load_dwordx4 v15, s[56:59], s46 offen lds
    s_add_u32 m0, s47, 18432
    s_add_u32 s46, s14, 524288
    buffer_load_dwordx4 v16, s[56:59], s46 offen lds
    s_add_u32 m0, s47, 19456
    s_add_u32 s46, s14, 524288
    buffer_load_dwordx4 v17, s[56:59], s46 offen lds
    s_waitcnt vmcnt(20)
    s_barrier
    s_add_u32 s13, s79, 3
    s_and_b32 s13, s13, 7
    s_lshl_b32 s13, s13, 19
    s_add_u32 m0, s47, 98304
    s_add_u32 s46, s13, 0
    buffer_load_dwordx4 v10, s[48:51], s46 offen lds
    s_add_u32 m0, s47, 99328
    s_add_u32 s46, s13, 16384
    buffer_load_dwordx4 v11, s[48:51], s46 offen lds
    s_add_u32 m0, s47, 100352
    s_add_u32 s46, s13, 32768
    buffer_load_dwordx4 v10, s[48:51], s46 offen lds
    s_add_u32 m0, s47, 101376
    s_add_u32 s46, s13, 49152
    buffer_load_dwordx4 v11, s[48:51], s46 offen lds
    s_add_u32 m0, s47, 32768
    s_add_u32 s46, s14, 8192
    buffer_load_dwordx4 v14, s[56:59], s46 offen lds
    s_add_u32 m0, s47, 33792
    s_add_u32 s46, s14, 8192
    buffer_load_dwordx4 v15, s[56:59], s46 offen lds
    s_add_u32 m0, s47, 34816
    s_add_u32 s46, s14, 8192
    buffer_load_dwordx4 v16, s[56:59], s46 offen lds
    s_add_u32 m0, s47, 35840
    s_add_u32 s46, s14, 8192
    buffer_load_dwordx4 v17, s[56:59], s46 offen lds
    s_waitcnt vmcnt(24)
    s_waitcnt vmcnt(12)
    s_barrier
    s_add_u32 s13, s79, 3
    s_and_b32 s13, s13, 7
    s_lshl_b32 s13, s13, 19
    s_add_u32 m0, s47, 114688
    s_add_u32 s46, s13, 262144
    buffer_load_dwordx4 v10, s[48:51], s46 offen lds
    s_add_u32 m0, s47, 115712
    s_add_u32 s46, s13, 278528
    buffer_load_dwordx4 v11, s[48:51], s46 offen lds
    s_add_u32 m0, s47, 116736
    s_add_u32 s46, s13, 294912
    buffer_load_dwordx4 v10, s[48:51], s46 offen lds
    s_add_u32 m0, s47, 117760
    s_add_u32 s46, s13, 311296
    buffer_load_dwordx4 v11, s[48:51], s46 offen lds
    s_add_u32 s13, s79, 3
    s_and_b32 s13, s13, 7
    s_lshl_b32 s13, s13, 7
    s_add_u32 m0, s47, 147456
    s_add_u32 s46, s13, 0
    buffer_load_dwordx4 v12, s[52:55], s46 offen lds
    s_add_u32 m0, s47, 148480
    s_add_u32 s46, s13, 8192
    buffer_load_dwordx4 v13, s[52:55], s46 offen lds
    s_add_u32 m0, s47, 149504
    s_add_u32 s46, s13, 16384
    buffer_load_dwordx4 v12, s[52:55], s46 offen lds
    s_add_u32 m0, s47, 150528
    s_add_u32 s46, s13, 24576
    buffer_load_dwordx4 v13, s[52:55], s46 offen lds
    s_barrier
    s_add_u32 s13, s79, 4
    s_and_b32 s13, s13, 7
    s_lshl_b32 s13, s13, 19
    s_add_u32 m0, s47, 65536
    s_add_u32 s46, s13, 0
    buffer_load_dwordx4 v10, s[48:51], s46 offen lds
    s_add_u32 m0, s47, 66560
    s_add_u32 s46, s13, 16384
    buffer_load_dwordx4 v11, s[48:51], s46 offen lds
    s_add_u32 m0, s47, 67584
    s_add_u32 s46, s13, 32768
    buffer_load_dwordx4 v10, s[48:51], s46 offen lds
    s_add_u32 m0, s47, 68608
    s_add_u32 s46, s13, 49152
    buffer_load_dwordx4 v11, s[48:51], s46 offen lds
    s_add_u32 m0, s47, 49152
    s_add_u32 s46, s14, 532480
    buffer_load_dwordx4 v14, s[56:59], s46 offen lds
    s_add_u32 m0, s47, 50176
    s_add_u32 s46, s14, 532480
    buffer_load_dwordx4 v15, s[56:59], s46 offen lds
    s_add_u32 m0, s47, 51200
    s_add_u32 s46, s14, 532480
    buffer_load_dwordx4 v16, s[56:59], s46 offen lds
    s_add_u32 m0, s47, 52224
    s_add_u32 s46, s14, 532480
    buffer_load_dwordx4 v17, s[56:59], s46 offen lds
    s_waitcnt vmcnt(20)
    s_waitcnt vmcnt(8)
    s_barrier
    s_add_u32 s13, s79, 4
    s_and_b32 s13, s13, 7
    s_lshl_b32 s13, s13, 19
    s_add_u32 m0, s47, 81920
    s_add_u32 s46, s13, 262144
    buffer_load_dwordx4 v10, s[48:51], s46 offen lds
    s_add_u32 m0, s47, 82944
    s_add_u32 s46, s13, 278528
    buffer_load_dwordx4 v11, s[48:51], s46 offen lds
    s_add_u32 m0, s47, 83968
    s_add_u32 s46, s13, 294912
    buffer_load_dwordx4 v10, s[48:51], s46 offen lds
    s_add_u32 m0, s47, 84992
    s_add_u32 s46, s13, 311296
    buffer_load_dwordx4 v11, s[48:51], s46 offen lds
    s_add_u32 s13, s79, 4
    s_and_b32 s13, s13, 7
    s_lshl_b32 s13, s13, 7
    s_add_u32 m0, s47, 131072
    s_add_u32 s46, s13, 0
    buffer_load_dwordx4 v12, s[52:55], s46 offen lds
    s_add_u32 m0, s47, 132096
    s_add_u32 s46, s13, 8192
    buffer_load_dwordx4 v13, s[52:55], s46 offen lds
    s_add_u32 m0, s47, 133120
    s_add_u32 s46, s13, 16384
    buffer_load_dwordx4 v12, s[52:55], s46 offen lds
    s_add_u32 m0, s47, 134144
    s_add_u32 s46, s13, 24576
    buffer_load_dwordx4 v13, s[52:55], s46 offen lds
    s_mov_b32 s46, 0
    buffer_load_dwordx4 v[32:35], v18, s[60:63], s46 offen
    s_mov_b32 s46, 1024
    buffer_load_dwordx4 v[36:39], v18, s[60:63], s46 offen
    s_mov_b32 s46, 2048
    buffer_load_dwordx4 v[40:43], v18, s[60:63], s46 offen
    s_mov_b32 s46, 3072
    buffer_load_dwordx4 v[44:47], v18, s[60:63], s46 offen
    s_barrier
    s_add_u32 s13, s79, 5
    s_and_b32 s13, s13, 7
    s_lshl_b32 s13, s13, 19
    s_add_u32 m0, s47, 98304
    s_add_u32 s46, s13, 0
    buffer_load_dwordx4 v10, s[48:51], s46 offen lds
    s_add_u32 m0, s47, 99328
    s_add_u32 s46, s13, 16384
    buffer_load_dwordx4 v11, s[48:51], s46 offen lds
    s_add_u32 m0, s47, 100352
    s_add_u32 s46, s13, 32768
    buffer_load_dwordx4 v10, s[48:51], s46 offen lds
    s_add_u32 m0, s47, 101376
    s_add_u32 s46, s13, 49152
    buffer_load_dwordx4 v11, s[48:51], s46 offen lds
    s_waitcnt vmcnt(20)
    s_waitcnt vmcnt(8)
    s_barrier
    s_add_u32 s13, s79, 5
    s_and_b32 s13, s13, 7
    s_lshl_b32 s13, s13, 19
    s_add_u32 m0, s47, 114688
    s_add_u32 s46, s13, 262144
    buffer_load_dwordx4 v10, s[48:51], s46 offen lds
    s_add_u32 m0, s47, 115712
    s_add_u32 s46, s13, 278528
    buffer_load_dwordx4 v11, s[48:51], s46 offen lds
    s_add_u32 m0, s47, 116736
    s_add_u32 s46, s13, 294912
    buffer_load_dwordx4 v10, s[48:51], s46 offen lds
    s_add_u32 m0, s47, 117760
    s_add_u32 s46, s13, 311296
    buffer_load_dwordx4 v11, s[48:51], s46 offen lds
    s_add_u32 s13, s79, 5
    s_and_b32 s13, s13, 7
    s_lshl_b32 s13, s13, 7
    s_add_u32 m0, s47, 147456
    s_add_u32 s46, s13, 0
    buffer_load_dwordx4 v12, s[52:55], s46 offen lds
    s_add_u32 m0, s47, 148480
    s_add_u32 s46, s13, 8192
    buffer_load_dwordx4 v13, s[52:55], s46 offen lds
    s_add_u32 m0, s47, 149504
    s_add_u32 s46, s13, 16384
    buffer_load_dwordx4 v12, s[52:55], s46 offen lds
    s_add_u32 m0, s47, 150528
    s_add_u32 s46, s13, 24576
    buffer_load_dwordx4 v13, s[52:55], s46 offen lds
    s_mov_b32 s46, 524288
    buffer_load_dwordx4 v[48:51], v18, s[60:63], s46 offen
    s_mov_b32 s46, 525312
    buffer_load_dwordx4 v[52:55], v18, s[60:63], s46 offen
    s_mov_b32 s46, 526336
    buffer_load_dwordx4 v[56:59], v18, s[60:63], s46 offen
    s_mov_b32 s46, 527360
    buffer_load_dwordx4 v[60:63], v18, s[60:63], s46 offen
    s_barrier
    s_add_u32 s13, s79, 6
    s_and_b32 s13, s13, 7
    s_lshl_b32 s13, s13, 19
    s_add_u32 m0, s47, 65536
    s_add_u32 s46, s13, 0
    buffer_load_dwordx4 v10, s[48:51], s46 offen lds
    s_add_u32 m0, s47, 66560
    s_add_u32 s46, s13, 16384
    buffer_load_dwordx4 v11, s[48:51], s46 offen lds
    s_add_u32 m0, s47, 67584
    s_add_u32 s46, s13, 32768
    buffer_load_dwordx4 v10, s[48:51], s46 offen lds
    s_add_u32 m0, s47, 68608
    s_add_u32 s46, s13, 49152
    buffer_load_dwordx4 v11, s[48:51], s46 offen lds
    s_mov_b32 s46, 8192
    buffer_load_dwordx4 v[64:67], v18, s[60:63], s46 offen
    s_mov_b32 s46, 9216
    buffer_load_dwordx4 v[68:71], v18, s[60:63], s46 offen
    s_mov_b32 s46, 10240
    buffer_load_dwordx4 v[72:75], v18, s[60:63], s46 offen
    s_mov_b32 s46, 11264
    buffer_load_dwordx4 v[76:79], v18, s[60:63], s46 offen
    s_waitcnt vmcnt(20)
    s_waitcnt vmcnt(12)
    s_barrier
    s_add_u32 s13, s79, 6
    s_and_b32 s13, s13, 7
    s_lshl_b32 s13, s13, 19
    s_add_u32 m0, s47, 81920
    s_add_u32 s46, s13, 262144
    buffer_load_dwordx4 v10, s[48:51], s46 offen lds
    s_add_u32 m0, s47, 82944
    s_add_u32 s46, s13, 278528
    buffer_load_dwordx4 v11, s[48:51], s46 offen lds
    s_add_u32 m0, s47, 83968
    s_add_u32 s46, s13, 294912
    buffer_load_dwordx4 v10, s[48:51], s46 offen lds
    s_add_u32 m0, s47, 84992
    s_add_u32 s46, s13, 311296
    buffer_load_dwordx4 v11, s[48:51], s46 offen lds
    s_add_u32 s13, s79, 6
    s_and_b32 s13, s13, 7
    s_lshl_b32 s13, s13, 7
    s_add_u32 m0, s47, 131072
    s_add_u32 s46, s13, 0
    buffer_load_dwordx4 v12, s[52:55], s46 offen lds
    s_add_u32 m0, s47, 132096
    s_add_u32 s46, s13, 8192
    buffer_load_dwordx4 v13, s[52:55], s46 offen lds
    s_add_u32 m0, s47, 133120
    s_add_u32 s46, s13, 16384
    buffer_load_dwordx4 v12, s[52:55], s46 offen lds
    s_add_u32 m0, s47, 134144
    s_add_u32 s46, s13, 24576
    buffer_load_dwordx4 v13, s[52:55], s46 offen lds
    s_mov_b32 s46, 532480
    buffer_load_dwordx4 v[80:83], v18, s[60:63], s46 offen
    s_mov_b32 s46, 533504
    buffer_load_dwordx4 v[84:87], v18, s[60:63], s46 offen
    s_mov_b32 s46, 534528
    buffer_load_dwordx4 v[88:91], v18, s[60:63], s46 offen
    s_mov_b32 s46, 535552
    buffer_load_dwordx4 v[92:95], v18, s[60:63], s46 offen
    s_barrier
    s_add_u32 s13, s79, 7
    s_and_b32 s13, s13, 7
    s_lshl_b32 s13, s13, 19
    s_add_u32 m0, s47, 98304
    s_add_u32 s46, s13, 0
    buffer_load_dwordx4 v10, s[48:51], s46 offen lds
    s_add_u32 m0, s47, 99328
    s_add_u32 s46, s13, 16384
    buffer_load_dwordx4 v11, s[48:51], s46 offen lds
    s_add_u32 m0, s47, 100352
    s_add_u32 s46, s13, 32768
    buffer_load_dwordx4 v10, s[48:51], s46 offen lds
    s_add_u32 m0, s47, 101376
    s_add_u32 s46, s13, 49152
    buffer_load_dwordx4 v11, s[48:51], s46 offen lds
    s_waitcnt vmcnt(20)
    s_waitcnt vmcnt(8)
    s_barrier
    s_add_u32 s13, s79, 7
    s_and_b32 s13, s13, 7
    s_lshl_b32 s13, s13, 19
    s_add_u32 m0, s47, 114688
    s_add_u32 s46, s13, 262144
    buffer_load_dwordx4 v10, s[48:51], s46 offen lds
    s_add_u32 m0, s47, 115712
    s_add_u32 s46, s13, 278528
    buffer_load_dwordx4 v11, s[48:51], s46 offen lds
    s_add_u32 m0, s47, 116736
    s_add_u32 s46, s13, 294912
    buffer_load_dwordx4 v10, s[48:51], s46 offen lds
    s_add_u32 m0, s47, 117760
    s_add_u32 s46, s13, 311296
    buffer_load_dwordx4 v11, s[48:51], s46 offen lds
    s_add_u32 s13, s79, 7
    s_and_b32 s13, s13, 7
    s_lshl_b32 s13, s13, 7
    s_add_u32 m0, s47, 147456
    s_add_u32 s46, s13, 0
    buffer_load_dwordx4 v12, s[52:55], s46 offen lds
    s_add_u32 m0, s47, 148480
    s_add_u32 s46, s13, 8192
    buffer_load_dwordx4 v13, s[52:55], s46 offen lds
    s_add_u32 m0, s47, 149504
    s_add_u32 s46, s13, 16384
    buffer_load_dwordx4 v12, s[52:55], s46 offen lds
    s_add_u32 m0, s47, 150528
    s_add_u32 s46, s13, 24576
    buffer_load_dwordx4 v13, s[52:55], s46 offen lds
    s_barrier
    ds_write_b128 v20, v[32:35]
    ds_write_b128 v20, v[36:39] offset:1024
    ds_write_b128 v20, v[40:43] offset:2048
    ds_write_b128 v20, v[44:47] offset:3072
    s_lshr_b32 s80, s41, 2
    s_and_b32 s81, s41, 3
    s_lshl_b32 s44, s80, 20
    s_lshl_b32 s45, s81, 8
    s_add_u32 s44, s44, s45
    s_add_u32 s48, s24, s44
    s_addc_u32 s49, s25, 0
    s_sub_u32 s50, 4194304, s44
    s_mov_b32 s51, 0x20000
    s_lshl_b32 s44, s40, 23
    s_lshl_b32 s45, s42, 20
    s_add_u32 s44, s44, s45
    s_lshl_b32 s45, s80, 16
    s_add_u32 s44, s44, s45
    s_add_u32 s52, s38, s44
    s_addc_u32 s53, s39, 0
    s_sub_u32 s54, 16777216, s44
    s_mov_b32 s55, 0x20000
    s_lshl_b32 s82, s40, 3
    s_add_u32 s82, s82, s42
    s_lshl_b32 s82, s82, 2
    s_add_u32 s82, s82, s81
    s_lshl_b32 s44, s82, 18
    s_add_u32 s44, s44, 33554432
    s_add_u32 s56, s38, s44
    s_addc_u32 s57, s39, 0
    s_sub_u32 s58, 50331648, s44
    s_mov_b32 s59, 0x20000
    s_lshl_b32 s44, s82, 7
    s_add_u32 s44, s44, 58720256
    s_add_u32 s60, s38, s44
    s_addc_u32 s61, s39, 0
    s_sub_u32 s62, 58851328, s44
    s_mov_b32 s63, 0x20000
    s_lshl_b32 s44, s42, 18
    s_lshl_b32 s45, s40, 10
    s_add_u32 s44, s44, s45
    s_lshl_b32 s45, s81, 8
    s_add_u32 s44, s44, s45
    s_add_u32 s64, s36, s44
    s_addc_u32 s65, s37, 0
    s_sub_u32 s66, 2097152, s44
    s_mov_b32 s67, 0x20000
    v_lshrrev_b32 v2, 1, v1
    v_lshlrev_b32 v2, 10, v2
    v_and_b32 v3, 1, v1
    v_lshlrev_b32 v3, 7, v3
    v_add_u32 v2, v2, v3
    s_sub_u32 s44, s43, 4
    s_lshl_b32 s44, s44, 15
    s_lshl_b32 s45, s42, 17
    s_add_u32 s44, s44, s45
    buffer_load_dword v24, v2, s[48:51], s44 offen
    s_waitcnt vmcnt(9)
    s_waitcnt vmcnt(1)
    s_waitcnt lgkmcnt(0)
    s_barrier
    ds_write_b128 v20, v[48:51] offset:16384
    ds_write_b128 v20, v[52:55] offset:17408
    ds_write_b128 v20, v[56:59] offset:18432
    ds_write_b128 v20, v[60:63] offset:19456
    ds_write_b128 v21, v[64:67]
    ds_write_b128 v21, v[68:71] offset:1024
    ds_write_b128 v21, v[72:75] offset:2048
    ds_write_b128 v21, v[76:79] offset:3072
    s_waitcnt lgkmcnt(0)
    s_barrier
    ds_write_b128 v20, v[80:83] offset:32768
    ds_write_b128 v20, v[84:87] offset:33792
    ds_write_b128 v20, v[88:91] offset:34816
    ds_write_b128 v20, v[92:95] offset:35840
    s_waitcnt lgkmcnt(0)
    s_barrier
    s_sub_u32 s44, s43, 4
    s_mov_b32 s45, 65536
    s_cmp_eq_u32 s44, 1
    s_cselect_b32 s45, 81920, s45
    s_cmp_eq_u32 s44, 2
    s_cselect_b32 s45, 131072, s45
    s_cmp_eq_u32 s44, 3
    s_cselect_b32 s45, 98304, s45
    v_bfe_u32 v189, v1, 2, 2
    v_lshrrev_b32 v190, 5, v1
    v_lshlrev_b32 v190, 2, v190
    v_add_u32 v190, v190, v189
    v_lshlrev_b32 v190, 8, v190
    v_add_u32 v190, s45, v190
    v_bfe_u32 v191, v1, 4, 1
    v_lshlrev_b32 v191, 5, v191
    v_add_u32 v190, v190, v191
    v_and_b32 v191, 3, v1
    v_lshlrev_b32 v191, 3, v191
    v_add_u32 v190, v190, v191
    v_lshlrev_b32 v189, 6, v189
    v_xor_b32 v184, 0, v189
    v_add_u32 v184, v184, v190
    v_xor_b32 v185, 64, v189
    v_add_u32 v185, v185, v190
    v_xor_b32 v186, 128, v189
    v_add_u32 v186, v186, v190
    v_xor_b32 v187, 192, v189
    v_add_u32 v187, v187, v190
    v_lshlrev_b32 v188, 4, v1
    s_lshr_b32 s45, s44, 1
    s_lshl_b32 s45, s45, 15
    s_and_b32 s46, s44, 1
    s_lshl_b32 s46, s46, 13
    s_add_u32 s45, s45, s46
    v_add_u32 v188, s45, v188
    s_mov_b32 s76, 0x3e0293ee
    s_waitcnt lgkmcnt(0)
    s_barrier
    ds_read_b64_tr_b16 v[144:145], v184 offset:8192
    ds_read_b64_tr_b16 v[146:147], v184 offset:10240
    ds_read_b64_tr_b16 v[152:153], v185 offset:8192
    ds_read_b64_tr_b16 v[154:155], v185 offset:10240
    ds_read_b64_tr_b16 v[160:161], v186 offset:8192
    ds_read_b64_tr_b16 v[162:163], v186 offset:10240
    ds_read_b64_tr_b16 v[168:169], v187 offset:8192
    ds_read_b64_tr_b16 v[170:171], v187 offset:10240
    ds_read_b64_tr_b16 v[148:149], v184 offset:12288
    ds_read_b64_tr_b16 v[150:151], v184 offset:14336
    ds_read_b64_tr_b16 v[156:157], v185 offset:12288
    ds_read_b64_tr_b16 v[158:159], v185 offset:14336
    ds_read_b64_tr_b16 v[164:165], v186 offset:12288
    ds_read_b64_tr_b16 v[166:167], v186 offset:14336
    ds_read_b64_tr_b16 v[172:173], v187 offset:12288
    ds_read_b64_tr_b16 v[174:175], v187 offset:14336
    s_lshl_b32 s44, s40, 2
    s_add_u32 s44, s44, s80
    s_lshl_b32 s44, s44, 3
    s_add_u32 s44, s44, s42
    s_lshl_b32 s44, s44, 8
    s_add_u32 s44, s44, 59768832
    s_add_u32 s8, s38, s44
    s_addc_u32 s9, s39, 0
    s_sub_u32 s10, 60030976, s44
    s_mov_b32 s11, 0x20000
    s_lshl_b32 s79, s81, 1
    s_sub_u32 s44, s43, 4
    v_lshrrev_b32 v4, 4, v1
    v_and_b32 v3, 15, v1
    v_lshlrev_b32 v2, 2, v4
    v_xor_b32 v3, v3, v2
    v_lshlrev_b32 v3, 4, v3
    v_lshlrev_b32 v2, 10, v4
    v_add_u32 v10, v2, v3
    s_lshl_b32 s45, s44, 14
    v_add_u32 v10, s45, v10
    v_lshlrev_b32 v11, 4, v1
    s_lshl_b32 s45, s44, 18
    v_add_u32 v11, s45, v11
    s_lshl_b32 s47, s44, 12
    s_add_u32 s13, s79, 0
    s_and_b32 s13, s13, 7
    s_lshl_b32 s14, s13, 17
    s_add_u32 m0, s47, 114688
    s_add_u32 s46, s14, 0
    buffer_load_dwordx4 v10, s[48:51], s46 offen lds
    s_add_u32 m0, s47, 115712
    s_add_u32 s46, s14, 4096
    buffer_load_dwordx4 v10, s[48:51], s46 offen lds
    s_add_u32 m0, s47, 116736
    s_add_u32 s46, s14, 8192
    buffer_load_dwordx4 v10, s[48:51], s46 offen lds
    s_add_u32 m0, s47, 117760
    s_add_u32 s46, s14, 12288
    buffer_load_dwordx4 v10, s[48:51], s46 offen lds
    s_add_u32 s13, s79, 0
    s_and_b32 s13, s13, 7
    s_lshl_b32 s14, s13, 17
    s_add_u32 m0, s47, 147456
    s_add_u32 s46, s14, 65536
    buffer_load_dwordx4 v10, s[48:51], s46 offen lds
    s_add_u32 m0, s47, 148480
    s_add_u32 s46, s14, 69632
    buffer_load_dwordx4 v10, s[48:51], s46 offen lds
    s_add_u32 m0, s47, 149504
    s_add_u32 s46, s14, 73728
    buffer_load_dwordx4 v10, s[48:51], s46 offen lds
    s_add_u32 m0, s47, 150528
    s_add_u32 s46, s14, 77824
    buffer_load_dwordx4 v10, s[48:51], s46 offen lds
    v_mov_b32 v12, 0
    buffer_load_dwordx2 v[14:15], v12, s[4:7], 0 offen sc1
    v_and_b32 v18, 15, v1
    v_lshlrev_b32 v18, 3, v18
    v_lshlrev_b32 v19, 4, v1
    s_sub_u32 s44, s43, 4
    s_lshl_b32 s45, s44, 12
    v_add_u32 v20, s45, v19
    s_lshl_b32 s15, s81, 14
    s_lshl_b32 s45, s44, 18
    s_add_u32 s15, s15, s45
    s_lshl_b32 s88, s81, 2
    s_add_u32 s88, s88, s44
    s_lshl_b32 s88, s88, 3
    s_add_u32 s89, s88, 128
    s_mov_b32 s90, 128
    v_mov_b32 v21, 131072
    s_barrier
    ds_read_b128 v[128:131], v188 offset:4096
    ds_read_b128 v[132:135], v188 offset:5120
    ds_read_b128 v[136:139], v188 offset:6144
    ds_read_b128 v[140:143], v188 offset:7168
    s_waitcnt lgkmcnt(3)
    v_max3_f32 v189, v128, v129, v130
    s_waitcnt lgkmcnt(2)
    v_max3_f32 v190, v131, v132, v133
    s_waitcnt lgkmcnt(1)
    v_max3_f32 v191, v134, v135, v136
    v_max3_f32 v9, v137, v138, v139
    s_waitcnt lgkmcnt(0)
    v_max3_f32 v189, v189, v140, v141
    v_max3_f32 v190, v190, v142, v143
    v_max3_f32 v189, v189, v191, v9
    v_max_f32 v189, v189, v190
    v_mov_b32 v190, v189
    s_nop 1
    v_permlane32_swap_b32 v190, v189
    v_max_f32 v189, v189, v190
    v_mul_f32 v189, s76, v189
    v_fma_f32 v128, v128, s76, -v189
    v_fma_f32 v129, v129, s76, -v189
    v_fma_f32 v130, v130, s76, -v189
    v_fma_f32 v131, v131, s76, -v189
    v_fma_f32 v132, v132, s76, -v189
    v_fma_f32 v133, v133, s76, -v189
    v_fma_f32 v134, v134, s76, -v189
    v_fma_f32 v135, v135, s76, -v189
    v_fma_f32 v136, v136, s76, -v189
    v_fma_f32 v137, v137, s76, -v189
    v_fma_f32 v138, v138, s76, -v189
    v_fma_f32 v139, v139, s76, -v189
    v_fma_f32 v140, v140, s76, -v189
    v_fma_f32 v141, v141, s76, -v189
    v_fma_f32 v142, v142, s76, -v189
    v_fma_f32 v143, v143, s76, -v189
    v_exp_f32 v128, v128
    v_exp_f32 v129, v129
    v_exp_f32 v130, v130
    v_exp_f32 v131, v131
    v_exp_f32 v132, v132
    v_exp_f32 v133, v133
    v_exp_f32 v134, v134
    v_exp_f32 v135, v135
    v_exp_f32 v136, v136
    v_exp_f32 v137, v137
    v_exp_f32 v138, v138
    v_exp_f32 v139, v139
    v_exp_f32 v140, v140
    v_exp_f32 v141, v141
    v_exp_f32 v142, v142
    v_exp_f32 v143, v143
    v_add_f32 v191, v128, v129
    v_add_f32 v9, v130, v131
    v_add_f32 v189, v132, v133
    v_add_f32 v190, v134, v135
    v_add_f32 v191, v191, v136
    v_add_f32 v9, v9, v137
    v_add_f32 v189, v189, v138
    v_add_f32 v190, v190, v139
    v_add_f32 v191, v191, v140
    v_add_f32 v9, v9, v141
    v_add_f32 v189, v189, v142
    v_add_f32 v190, v190, v143
    v_add_f32 v191, v191, v9
    v_add_f32 v189, v189, v190
    v_add_f32 v191, v191, v189
    v_mov_b32 v9, v191
    s_nop 1
    v_permlane32_swap_b32 v9, v191
    v_add_f32 v191, v191, v9
    v_rcp_f32 v191, v191
    s_nop 0
    v_mul_f32 v128, v128, v191
    v_mul_f32 v129, v129, v191
    v_cvt_pk_bf16_f32 v176, v128, v129
    v_mul_f32 v130, v130, v191
    v_mul_f32 v131, v131, v191
    v_cvt_pk_bf16_f32 v177, v130, v131
    v_mul_f32 v132, v132, v191
    v_mul_f32 v133, v133, v191
    v_cvt_pk_bf16_f32 v178, v132, v133
    v_mul_f32 v134, v134, v191
    v_mul_f32 v135, v135, v191
    v_cvt_pk_bf16_f32 v179, v134, v135
    v_mul_f32 v136, v136, v191
    v_mul_f32 v137, v137, v191
    v_cvt_pk_bf16_f32 v180, v136, v137
    v_mul_f32 v138, v138, v191
    v_mul_f32 v139, v139, v191
    v_cvt_pk_bf16_f32 v181, v138, v139
    v_mul_f32 v140, v140, v191
    v_mul_f32 v141, v141, v191
    v_cvt_pk_bf16_f32 v182, v140, v141
    v_mul_f32 v142, v142, v191
    v_mul_f32 v143, v143, v191
    v_cvt_pk_bf16_f32 v183, v142, v143
    v_mfma_f32_32x32x16_bf16 v[192:207], v[144:147], v[176:179], 0
    v_mfma_f32_32x32x16_bf16 v[208:223], v[152:155], v[176:179], 0
    v_mfma_f32_32x32x16_bf16 v[192:207], v[148:151], v[180:183], v[192:207]
    v_mfma_f32_32x32x16_bf16 v[208:223], v[156:159], v[180:183], v[208:223]
    v_mfma_f32_32x32x16_bf16 v[224:239], v[160:163], v[176:179], 0
    v_mfma_f32_32x32x16_bf16 v[240:255], v[168:171], v[176:179], 0
    v_mfma_f32_32x32x16_bf16 v[224:239], v[164:167], v[180:183], v[224:239]
    v_mfma_f32_32x32x16_bf16 v[240:255], v[172:175], v[180:183], v[240:255]
    s_nop 6
    v_cvt_pk_bf16_f32 v96, v192, v193
    v_cvt_pk_bf16_f32 v97, v194, v195
    v_cvt_pk_bf16_f32 v98, v196, v197
    v_cvt_pk_bf16_f32 v99, v198, v199
    ds_write_b128 v188, v[96:99] offset:4096
    v_cvt_pk_bf16_f32 v100, v200, v201
    v_cvt_pk_bf16_f32 v101, v202, v203
    v_cvt_pk_bf16_f32 v102, v204, v205
    v_cvt_pk_bf16_f32 v103, v206, v207
    ds_write_b128 v188, v[100:103] offset:5120
    v_cvt_pk_bf16_f32 v104, v208, v209
    v_cvt_pk_bf16_f32 v105, v210, v211
    v_cvt_pk_bf16_f32 v106, v212, v213
    v_cvt_pk_bf16_f32 v107, v214, v215
    ds_write_b128 v188, v[104:107] offset:6144
    v_cvt_pk_bf16_f32 v108, v216, v217
    v_cvt_pk_bf16_f32 v109, v218, v219
    v_cvt_pk_bf16_f32 v110, v220, v221
    v_cvt_pk_bf16_f32 v111, v222, v223
    ds_write_b128 v188, v[108:111] offset:7168
    v_cvt_pk_bf16_f32 v112, v224, v225
    v_cvt_pk_bf16_f32 v113, v226, v227
    v_cvt_pk_bf16_f32 v114, v228, v229
    v_cvt_pk_bf16_f32 v115, v230, v231
    ds_write_b128 v188, v[112:115] offset:20480
    v_cvt_pk_bf16_f32 v116, v232, v233
    v_cvt_pk_bf16_f32 v117, v234, v235
    v_cvt_pk_bf16_f32 v118, v236, v237
    v_cvt_pk_bf16_f32 v119, v238, v239
    ds_write_b128 v188, v[116:119] offset:21504
    v_cvt_pk_bf16_f32 v120, v240, v241
    v_cvt_pk_bf16_f32 v121, v242, v243
    v_cvt_pk_bf16_f32 v122, v244, v245
    v_cvt_pk_bf16_f32 v123, v246, v247
    ds_write_b128 v188, v[120:123] offset:22528
    v_cvt_pk_bf16_f32 v124, v248, v249
    v_cvt_pk_bf16_f32 v125, v250, v251
    v_cvt_pk_bf16_f32 v126, v252, v253
    v_cvt_pk_bf16_f32 v127, v254, v255
    ds_write_b128 v188, v[124:127] offset:23552
    s_waitcnt lgkmcnt(0)
    s_waitcnt vmcnt(0)
    s_mov_b32 s83, 0
FL_NONCE_p0:
    v_readfirstlane_b32 s84, v14
    v_readfirstlane_b32 s85, v15
    s_nop 3
    s_or_b32 s86, s84, s85
    s_cmp_lg_u32 s86, 0
    s_cbranch_scc1 FL_NONCE_OK_p0
    s_add_u32 s83, s83, 1
    s_cmp_gt_u32 s83, 200000
    s_cbranch_scc1 FL_NONCE_OK_p0
    s_sleep 4
    buffer_load_dwordx2 v[14:15], v12, s[4:7], 0 offen sc1
    s_waitcnt vmcnt(0)
    s_branch FL_NONCE_p0
FL_NONCE_OK_p0:
    v_mov_b32 v16, s84
    v_mov_b32 v17, s85
    s_barrier
    v_mov_b32 v22, 0
    ds_write_b32 v21, v22
    ds_write_b64 v21, v[16:17] offset:8
    s_add_u32 s13, s79, 1
    s_and_b32 s13, s13, 7
    s_lshl_b32 s14, s13, 17
    s_add_u32 m0, s47, 65536
    s_add_u32 s46, s14, 0
    buffer_load_dwordx4 v10, s[48:51], s46 offen lds
    s_add_u32 m0, s47, 66560
    s_add_u32 s46, s14, 4096
    buffer_load_dwordx4 v10, s[48:51], s46 offen lds
    s_add_u32 m0, s47, 67584
    s_add_u32 s46, s14, 8192
    buffer_load_dwordx4 v10, s[48:51], s46 offen lds
    s_add_u32 m0, s47, 68608
    s_add_u32 s46, s14, 12288
    buffer_load_dwordx4 v10, s[48:51], s46 offen lds
    s_add_u32 s13, s79, 1
    s_and_b32 s13, s13, 7
    s_lshl_b32 s14, s13, 17
    s_add_u32 m0, s47, 81920
    s_add_u32 s46, s14, 65536
    buffer_load_dwordx4 v10, s[48:51], s46 offen lds
    s_add_u32 m0, s47, 82944
    s_add_u32 s46, s14, 69632
    buffer_load_dwordx4 v10, s[48:51], s46 offen lds
    s_add_u32 m0, s47, 83968
    s_add_u32 s46, s14, 73728
    buffer_load_dwordx4 v10, s[48:51], s46 offen lds
    s_add_u32 m0, s47, 84992
    s_add_u32 s46, s14, 77824
    buffer_load_dwordx4 v10, s[48:51], s46 offen lds
    ds_read_b128 v[32:35], v20
    ds_read_b128 v[36:39], v20 offset:1024
    ds_read_b128 v[40:43], v20 offset:2048
    ds_read_b128 v[44:47], v20 offset:3072
    ds_read_b128 v[48:51], v20 offset:16384
    ds_read_b128 v[52:55], v20 offset:17408
    ds_read_b128 v[56:59], v20 offset:18432
    ds_read_b128 v[60:63], v20 offset:19456
    ds_read_b128 v[64:67], v20 offset:32768
    ds_read_b128 v[68:71], v20 offset:33792
    ds_read_b128 v[72:75], v20 offset:34816
    ds_read_b128 v[76:79], v20 offset:35840
    ds_read_b128 v[80:83], v20 offset:49152
    ds_read_b128 v[84:87], v20 offset:50176
    ds_read_b128 v[88:91], v20 offset:51200
    ds_read_b128 v[92:95], v20 offset:52224
    s_add_u32 s46, s15, 0
    s_waitcnt lgkmcnt(15)
    buffer_store_dwordx4 v[32:35], v19, s[52:55], s46 offen sc1
    s_add_u32 s46, s15, 0
    s_waitcnt lgkmcnt(14)
    buffer_store_dwordx4 v[36:39], v19, s[52:55], s46 offen offset:1024 sc1
    s_add_u32 s46, s15, 0
    s_waitcnt lgkmcnt(13)
    buffer_store_dwordx4 v[40:43], v19, s[52:55], s46 offen offset:2048 sc1
    s_add_u32 s46, s15, 0
    s_waitcnt lgkmcnt(12)
    buffer_store_dwordx4 v[44:47], v19, s[52:55], s46 offen offset:3072 sc1
    s_add_u32 s46, s15, 4096
    s_waitcnt lgkmcnt(11)
    buffer_store_dwordx4 v[48:51], v19, s[52:55], s46 offen sc1
    s_add_u32 s46, s15, 4096
    s_waitcnt lgkmcnt(10)
    buffer_store_dwordx4 v[52:55], v19, s[52:55], s46 offen offset:1024 sc1
    s_waitcnt lgkmcnt(0)
    s_barrier
    s_add_u32 s46, s15, 4096
    buffer_store_dwordx4 v[56:59], v19, s[52:55], s46 offen offset:2048 sc1
    s_add_u32 s46, s15, 4096
    buffer_store_dwordx4 v[60:63], v19, s[52:55], s46 offen offset:3072 sc1
    s_add_u32 s46, s15, 8192
    buffer_store_dwordx4 v[64:67], v19, s[52:55], s46 offen sc1
    s_add_u32 s46, s15, 8192
    buffer_store_dwordx4 v[68:71], v19, s[52:55], s46 offen offset:1024 sc1
    s_add_u32 s46, s15, 8192
    buffer_store_dwordx4 v[72:75], v19, s[52:55], s46 offen offset:2048 sc1
    s_waitcnt vmcnt(15)
    s_barrier
    s_add_u32 s46, s15, 8192
    buffer_store_dwordx4 v[76:79], v19, s[52:55], s46 offen offset:3072 sc1
    s_add_u32 s46, s15, 12288
    buffer_store_dwordx4 v[80:83], v19, s[52:55], s46 offen sc1
    s_add_u32 s46, s15, 12288
    buffer_store_dwordx4 v[84:87], v19, s[52:55], s46 offen offset:1024 sc1
    s_add_u32 s46, s15, 12288
    buffer_store_dwordx4 v[88:91], v19, s[52:55], s46 offen offset:2048 sc1
    s_add_u32 s46, s15, 12288
    buffer_store_dwordx4 v[92:95], v19, s[52:55], s46 offen offset:3072 sc1
    s_waitcnt vmcnt(16)
    s_barrier
    s_waitcnt vmcnt(0)
    v_cmp_eq_u32 vcc, 0, v1
    s_mov_b64 s[86:87], exec
    s_nop 2
    s_and_b64 exec, exec, vcc
    buffer_store_dwordx2 v[16:17], v12, s[8:11], s88 offen
    s_mov_b64 exec, s[86:87]
    s_cmp_lg_u32 s43, 4
    s_cbranch_scc1 FL_POLL0_W_p0
    s_mov_b32 s83, 0
FL_POLL0_p0:
    s_nop 4
    buffer_load_dwordx2 v[14:15], v18, s[8:11], 0 offen sc1
    s_waitcnt vmcnt(0)
    v_cmp_eq_u64 vcc, v[14:15], v[16:17]
    s_nop 4
    s_cmp_eq_u64 vcc, exec
    s_cbranch_scc1 FL_POLL0_OK_p0
    s_add_u32 s83, s83, 1
    s_cmp_lg_u32 s83, 8
    s_cbranch_scc1 FL_POLL0_NB_p0
    v_cmp_eq_u32 vcc, 0, v1
    s_mov_b64 s[86:87], exec
    s_nop 3
    s_and_b64 exec, exec, vcc
    buffer_store_dwordx2 v[16:17], v12, s[8:11], s88 offen sc1
    s_mov_b64 exec, s[86:87]
FL_POLL0_NB_p0:
    s_cmp_gt_u32 s83, 200000
    s_cbranch_scc1 FL_POLL0_OK_p0
    s_sleep 1
    s_branch FL_POLL0_p0
FL_POLL0_OK_p0:
    v_mov_b32 v22, 1
    ds_write_b32 v21, v22
    s_waitcnt lgkmcnt(0)
    s_branch FL_POLL0_D_p0
FL_POLL0_W_p0:
    s_mov_b32 s83, 0
FL_POLL0_L_p0:
    ds_read_b32 v22, v21
    s_waitcnt lgkmcnt(0)
    v_readfirstlane_b32 s86, v22
    s_nop 3
    s_cmp_ge_u32 s86, 1
    s_cbranch_scc1 FL_POLL0_D_p0
    s_add_u32 s83, s83, 1
    s_cmp_lg_u32 s83, 40
    s_cbranch_scc1 FL_POLL0_NB2_p0
    v_cmp_eq_u32 vcc, 0, v1
    s_mov_b64 s[86:87], exec
    s_nop 3
    s_and_b64 exec, exec, vcc
    buffer_store_dwordx2 v[16:17], v12, s[8:11], s88 offen sc1
    s_mov_b64 exec, s[86:87]
FL_POLL0_NB2_p0:
    s_cmp_gt_u32 s83, 4000000
    s_cbranch_scc1 FL_POLL0_D_p0
    s_sleep 1
    s_branch FL_POLL0_L_p0
FL_POLL0_D_p0:
    s_add_u32 s13, s79, 2
    s_and_b32 s13, s13, 7
    s_lshl_b32 s14, s13, 17
    s_add_u32 m0, s47, 114688
    s_add_u32 s46, s14, 0
    buffer_load_dwordx4 v10, s[48:51], s46 offen lds
    s_add_u32 m0, s47, 115712
    s_add_u32 s46, s14, 4096
    buffer_load_dwordx4 v10, s[48:51], s46 offen lds
    s_add_u32 m0, s47, 116736
    s_add_u32 s46, s14, 8192
    buffer_load_dwordx4 v10, s[48:51], s46 offen lds
    s_add_u32 m0, s47, 117760
    s_add_u32 s46, s14, 12288
    buffer_load_dwordx4 v10, s[48:51], s46 offen lds
    s_lshl_b32 s14, s13, 13
    s_add_u32 m0, s47, 0
    s_add_u32 s46, s14, 0
    buffer_load_dwordx4 v11, s[52:55], s46 offen sc1 lds
    s_add_u32 m0, s47, 1024
    s_add_u32 s46, s14, 1024
    buffer_load_dwordx4 v11, s[52:55], s46 offen sc1 lds
    s_add_u32 m0, s47, 2048
    s_add_u32 s46, s14, 2048
    buffer_load_dwordx4 v11, s[52:55], s46 offen sc1 lds
    s_add_u32 m0, s47, 3072
    s_add_u32 s46, s14, 3072
    buffer_load_dwordx4 v11, s[52:55], s46 offen sc1 lds
    s_add_u32 s13, s79, 2
    s_and_b32 s13, s13, 7
    s_lshl_b32 s14, s13, 17
    s_add_u32 m0, s47, 147456
    s_add_u32 s46, s14, 65536
    buffer_load_dwordx4 v10, s[48:51], s46 offen lds
    s_add_u32 m0, s47, 148480
    s_add_u32 s46, s14, 69632
    buffer_load_dwordx4 v10, s[48:51], s46 offen lds
    s_add_u32 m0, s47, 149504
    s_add_u32 s46, s14, 73728
    buffer_load_dwordx4 v10, s[48:51], s46 offen lds
    s_add_u32 m0, s47, 150528
    s_add_u32 s46, s14, 77824
    buffer_load_dwordx4 v10, s[48:51], s46 offen lds
    s_lshl_b32 s14, s13, 13
    s_add_u32 m0, s47, 16384
    s_add_u32 s46, s14, 4096
    buffer_load_dwordx4 v11, s[52:55], s46 offen sc1 lds
    s_add_u32 m0, s47, 17408
    s_add_u32 s46, s14, 5120
    buffer_load_dwordx4 v11, s[52:55], s46 offen sc1 lds
    s_add_u32 m0, s47, 18432
    s_add_u32 s46, s14, 6144
    buffer_load_dwordx4 v11, s[52:55], s46 offen sc1 lds
    s_add_u32 m0, s47, 19456
    s_add_u32 s46, s14, 7168
    buffer_load_dwordx4 v11, s[52:55], s46 offen sc1 lds
    s_add_u32 s13, s79, 4
    s_and_b32 s13, s13, 7
    s_lshl_b32 s14, s13, 17
    s_add_u32 m0, s47, 65536
    s_add_u32 s46, s14, 0
    buffer_load_dwordx4 v10, s[48:51], s46 offen lds
    s_add_u32 m0, s47, 66560
    s_add_u32 s46, s14, 4096
    buffer_load_dwordx4 v10, s[48:51], s46 offen lds
    s_add_u32 m0, s47, 67584
    s_add_u32 s46, s14, 8192
    buffer_load_dwordx4 v10, s[48:51], s46 offen lds
    s_add_u32 m0, s47, 68608
    s_add_u32 s46, s14, 12288
    buffer_load_dwordx4 v10, s[48:51], s46 offen lds
    s_lshl_b32 s14, s13, 13
    s_add_u32 m0, s47, 32768
    s_add_u32 s46, s14, 0
    buffer_load_dwordx4 v11, s[52:55], s46 offen sc1 lds
    s_add_u32 m0, s47, 33792
    s_add_u32 s46, s14, 1024
    buffer_load_dwordx4 v11, s[52:55], s46 offen sc1 lds
    s_add_u32 m0, s47, 34816
    s_add_u32 s46, s14, 2048
    buffer_load_dwordx4 v11, s[52:55], s46 offen sc1 lds
    s_add_u32 m0, s47, 35840
    s_add_u32 s46, s14, 3072
    buffer_load_dwordx4 v11, s[52:55], s46 offen sc1 lds
    v_cmp_eq_u32 vcc, 0, v1
    s_mov_b64 s[86:87], exec
    s_nop 3
    s_and_b64 exec, exec, vcc
    buffer_store_dwordx2 v[16:17], v12, s[8:11], s88 offen sc1
    s_mov_b64 exec, s[86:87]
    s_waitcnt vmcnt(16)
    s_barrier
    s_add_u32 s13, s79, 4
    s_and_b32 s13, s13, 7
    s_lshl_b32 s14, s13, 17
    s_add_u32 m0, s47, 81920
    s_add_u32 s46, s14, 65536
    buffer_load_dwordx4 v10, s[48:51], s46 offen lds
    s_add_u32 m0, s47, 82944
    s_add_u32 s46, s14, 69632
    buffer_load_dwordx4 v10, s[48:51], s46 offen lds
    s_add_u32 m0, s47, 83968
    s_add_u32 s46, s14, 73728
    buffer_load_dwordx4 v10, s[48:51], s46 offen lds
    s_add_u32 m0, s47, 84992
    s_add_u32 s46, s14, 77824
    buffer_load_dwordx4 v10, s[48:51], s46 offen lds
    s_lshl_b32 s14, s13, 13
    s_add_u32 m0, s47, 49152
    s_add_u32 s46, s14, 4096
    buffer_load_dwordx4 v11, s[52:55], s46 offen sc1 lds
    s_add_u32 m0, s47, 50176
    s_add_u32 s46, s14, 5120
    buffer_load_dwordx4 v11, s[52:55], s46 offen sc1 lds
    s_add_u32 m0, s47, 51200
    s_add_u32 s46, s14, 6144
    buffer_load_dwordx4 v11, s[52:55], s46 offen sc1 lds
    s_add_u32 m0, s47, 52224
    s_add_u32 s46, s14, 7168
    buffer_load_dwordx4 v11, s[52:55], s46 offen sc1 lds
    s_waitcnt vmcnt(16)
    s_barrier
    s_add_u32 s13, s79, 6
    s_and_b32 s13, s13, 7
    s_lshl_b32 s14, s13, 17
    s_add_u32 m0, s47, 114688
    s_add_u32 s46, s14, 0
    buffer_load_dwordx4 v10, s[48:51], s46 offen lds
    s_add_u32 m0, s47, 115712
    s_add_u32 s46, s14, 4096
    buffer_load_dwordx4 v10, s[48:51], s46 offen lds
    s_add_u32 m0, s47, 116736
    s_add_u32 s46, s14, 8192
    buffer_load_dwordx4 v10, s[48:51], s46 offen lds
    s_add_u32 m0, s47, 117760
    s_add_u32 s46, s14, 12288
    buffer_load_dwordx4 v10, s[48:51], s46 offen lds
    s_lshl_b32 s14, s13, 13
    s_add_u32 m0, s47, 0
    s_add_u32 s46, s14, 0
    buffer_load_dwordx4 v11, s[52:55], s46 offen sc1 lds
    s_add_u32 m0, s47, 1024
    s_add_u32 s46, s14, 1024
    buffer_load_dwordx4 v11, s[52:55], s46 offen sc1 lds
    s_add_u32 m0, s47, 2048
    s_add_u32 s46, s14, 2048
    buffer_load_dwordx4 v11, s[52:55], s46 offen sc1 lds
    s_add_u32 m0, s47, 3072
    s_add_u32 s46, s14, 3072
    buffer_load_dwordx4 v11, s[52:55], s46 offen sc1 lds
    s_waitcnt vmcnt(16)
    s_barrier
    s_add_u32 s13, s79, 6
    s_and_b32 s13, s13, 7
    s_lshl_b32 s14, s13, 17
    s_add_u32 m0, s47, 147456
    s_add_u32 s46, s14, 65536
    buffer_load_dwordx4 v10, s[48:51], s46 offen lds
    s_add_u32 m0, s47, 148480
    s_add_u32 s46, s14, 69632
    buffer_load_dwordx4 v10, s[48:51], s46 offen lds
    s_add_u32 m0, s47, 149504
    s_add_u32 s46, s14, 73728
    buffer_load_dwordx4 v10, s[48:51], s46 offen lds
    s_add_u32 m0, s47, 150528
    s_add_u32 s46, s14, 77824
    buffer_load_dwordx4 v10, s[48:51], s46 offen lds
    s_lshl_b32 s14, s13, 13
    s_add_u32 m0, s47, 16384
    s_add_u32 s46, s14, 4096
    buffer_load_dwordx4 v11, s[52:55], s46 offen sc1 lds
    s_add_u32 m0, s47, 17408
    s_add_u32 s46, s14, 5120
    buffer_load_dwordx4 v11, s[52:55], s46 offen sc1 lds
    s_add_u32 m0, s47, 18432
    s_add_u32 s46, s14, 6144
    buffer_load_dwordx4 v11, s[52:55], s46 offen sc1 lds
    s_add_u32 m0, s47, 19456
    s_add_u32 s46, s14, 7168
    buffer_load_dwordx4 v11, s[52:55], s46 offen sc1 lds
    s_waitcnt vmcnt(16)
    s_barrier
    s_add_u32 s13, s79, 3
    s_and_b32 s13, s13, 7
    s_lshl_b32 s14, s13, 17
    s_add_u32 m0, s47, 65536
    s_add_u32 s46, s14, 0
    buffer_load_dwordx4 v10, s[48:51], s46 offen lds
    s_add_u32 m0, s47, 66560
    s_add_u32 s46, s14, 4096
    buffer_load_dwordx4 v10, s[48:51], s46 offen lds
    s_add_u32 m0, s47, 67584
    s_add_u32 s46, s14, 8192
    buffer_load_dwordx4 v10, s[48:51], s46 offen lds
    s_add_u32 m0, s47, 68608
    s_add_u32 s46, s14, 12288
    buffer_load_dwordx4 v10, s[48:51], s46 offen lds
    s_lshl_b32 s14, s13, 13
    s_add_u32 m0, s47, 32768
    s_add_u32 s46, s14, 0
    buffer_load_dwordx4 v11, s[52:55], s46 offen sc1 lds
    s_add_u32 m0, s47, 33792
    s_add_u32 s46, s14, 1024
    buffer_load_dwordx4 v11, s[52:55], s46 offen sc1 lds
    s_add_u32 m0, s47, 34816
    s_add_u32 s46, s14, 2048
    buffer_load_dwordx4 v11, s[52:55], s46 offen sc1 lds
    s_add_u32 m0, s47, 35840
    s_add_u32 s46, s14, 3072
    buffer_load_dwordx4 v11, s[52:55], s46 offen sc1 lds
    s_waitcnt vmcnt(16)
    s_barrier
    s_add_u32 s13, s79, 3
    s_and_b32 s13, s13, 7
    s_lshl_b32 s14, s13, 17
    s_add_u32 m0, s47, 81920
    s_add_u32 s46, s14, 65536
    buffer_load_dwordx4 v10, s[48:51], s46 offen lds
    s_add_u32 m0, s47, 82944
    s_add_u32 s46, s14, 69632
    buffer_load_dwordx4 v10, s[48:51], s46 offen lds
    s_add_u32 m0, s47, 83968
    s_add_u32 s46, s14, 73728
    buffer_load_dwordx4 v10, s[48:51], s46 offen lds
    s_add_u32 m0, s47, 84992
    s_add_u32 s46, s14, 77824
    buffer_load_dwordx4 v10, s[48:51], s46 offen lds
    s_lshl_b32 s14, s13, 13
    s_add_u32 m0, s47, 49152
    s_add_u32 s46, s14, 4096
    buffer_load_dwordx4 v11, s[52:55], s46 offen sc1 lds
    s_add_u32 m0, s47, 50176
    s_add_u32 s46, s14, 5120
    buffer_load_dwordx4 v11, s[52:55], s46 offen sc1 lds
    s_add_u32 m0, s47, 51200
    s_add_u32 s46, s14, 6144
    buffer_load_dwordx4 v11, s[52:55], s46 offen sc1 lds
    s_add_u32 m0, s47, 52224
    s_add_u32 s46, s14, 7168
    buffer_load_dwordx4 v11, s[52:55], s46 offen sc1 lds
    s_waitcnt vmcnt(16)
    s_barrier
    s_add_u32 s13, s79, 5
    s_and_b32 s13, s13, 7
    s_lshl_b32 s14, s13, 17
    s_add_u32 m0, s47, 114688
    s_add_u32 s46, s14, 0
    buffer_load_dwordx4 v10, s[48:51], s46 offen lds
    s_add_u32 m0, s47, 115712
    s_add_u32 s46, s14, 4096
    buffer_load_dwordx4 v10, s[48:51], s46 offen lds
    s_add_u32 m0, s47, 116736
    s_add_u32 s46, s14, 8192
    buffer_load_dwordx4 v10, s[48:51], s46 offen lds
    s_add_u32 m0, s47, 117760
    s_add_u32 s46, s14, 12288
    buffer_load_dwordx4 v10, s[48:51], s46 offen lds
    s_lshl_b32 s14, s13, 13
    s_add_u32 m0, s47, 0
    s_add_u32 s46, s14, 0
    buffer_load_dwordx4 v11, s[52:55], s46 offen sc1 lds
    s_add_u32 m0, s47, 1024
    s_add_u32 s46, s14, 1024
    buffer_load_dwordx4 v11, s[52:55], s46 offen sc1 lds
    s_add_u32 m0, s47, 2048
    s_add_u32 s46, s14, 2048
    buffer_load_dwordx4 v11, s[52:55], s46 offen sc1 lds
    s_add_u32 m0, s47, 3072
    s_add_u32 s46, s14, 3072
    buffer_load_dwordx4 v11, s[52:55], s46 offen sc1 lds
    s_waitcnt vmcnt(16)
    s_barrier
    s_add_u32 s13, s79, 5
    s_and_b32 s13, s13, 7
    s_lshl_b32 s14, s13, 17
    s_add_u32 m0, s47, 147456
    s_add_u32 s46, s14, 65536
    buffer_load_dwordx4 v10, s[48:51], s46 offen lds
    s_add_u32 m0, s47, 148480
    s_add_u32 s46, s14, 69632
    buffer_load_dwordx4 v10, s[48:51], s46 offen lds
    s_add_u32 m0, s47, 149504
    s_add_u32 s46, s14, 73728
    buffer_load_dwordx4 v10, s[48:51], s46 offen lds
    s_add_u32 m0, s47, 150528
    s_add_u32 s46, s14, 77824
    buffer_load_dwordx4 v10, s[48:51], s46 offen lds
    s_lshl_b32 s14, s13, 13
    s_add_u32 m0, s47, 16384
    s_add_u32 s46, s14, 4096
    buffer_load_dwordx4 v11, s[52:55], s46 offen sc1 lds
    s_add_u32 m0, s47, 17408
    s_add_u32 s46, s14, 5120
    buffer_load_dwordx4 v11, s[52:55], s46 offen sc1 lds
    s_add_u32 m0, s47, 18432
    s_add_u32 s46, s14, 6144
    buffer_load_dwordx4 v11, s[52:55], s46 offen sc1 lds
    s_add_u32 m0, s47, 19456
    s_add_u32 s46, s14, 7168
    buffer_load_dwordx4 v11, s[52:55], s46 offen sc1 lds
    s_waitcnt vmcnt(16)
    s_barrier
    s_add_u32 s13, s79, 7
    s_and_b32 s13, s13, 7
    s_lshl_b32 s14, s13, 17
    s_add_u32 m0, s47, 65536
    s_add_u32 s46, s14, 0
    buffer_load_dwordx4 v10, s[48:51], s46 offen lds
    s_add_u32 m0, s47, 66560
    s_add_u32 s46, s14, 4096
    buffer_load_dwordx4 v10, s[48:51], s46 offen lds
    s_add_u32 m0, s47, 67584
    s_add_u32 s46, s14, 8192
    buffer_load_dwordx4 v10, s[48:51], s46 offen lds
    s_add_u32 m0, s47, 68608
    s_add_u32 s46, s14, 12288
    buffer_load_dwordx4 v10, s[48:51], s46 offen lds
    s_lshl_b32 s14, s13, 13
    s_add_u32 m0, s47, 32768
    s_add_u32 s46, s14, 0
    buffer_load_dwordx4 v11, s[52:55], s46 offen sc1 lds
    s_add_u32 m0, s47, 33792
    s_add_u32 s46, s14, 1024
    buffer_load_dwordx4 v11, s[52:55], s46 offen sc1 lds
    s_add_u32 m0, s47, 34816
    s_add_u32 s46, s14, 2048
    buffer_load_dwordx4 v11, s[52:55], s46 offen sc1 lds
    s_add_u32 m0, s47, 35840
    s_add_u32 s46, s14, 3072
    buffer_load_dwordx4 v11, s[52:55], s46 offen sc1 lds
    s_waitcnt vmcnt(16)
    s_barrier
    s_add_u32 s13, s79, 7
    s_and_b32 s13, s13, 7
    s_lshl_b32 s14, s13, 17
    s_add_u32 m0, s47, 81920
    s_add_u32 s46, s14, 65536
    buffer_load_dwordx4 v10, s[48:51], s46 offen lds
    s_add_u32 m0, s47, 82944
    s_add_u32 s46, s14, 69632
    buffer_load_dwordx4 v10, s[48:51], s46 offen lds
    s_add_u32 m0, s47, 83968
    s_add_u32 s46, s14, 73728
    buffer_load_dwordx4 v10, s[48:51], s46 offen lds
    s_add_u32 m0, s47, 84992
    s_add_u32 s46, s14, 77824
    buffer_load_dwordx4 v10, s[48:51], s46 offen lds
    s_lshl_b32 s14, s13, 13
    s_add_u32 m0, s47, 49152
    s_add_u32 s46, s14, 4096
    buffer_load_dwordx4 v11, s[52:55], s46 offen sc1 lds
    s_add_u32 m0, s47, 50176
    s_add_u32 s46, s14, 5120
    buffer_load_dwordx4 v11, s[52:55], s46 offen sc1 lds
    s_add_u32 m0, s47, 51200
    s_add_u32 s46, s14, 6144
    buffer_load_dwordx4 v11, s[52:55], s46 offen sc1 lds
    s_add_u32 m0, s47, 52224
    s_add_u32 s46, s14, 7168
    buffer_load_dwordx4 v11, s[52:55], s46 offen sc1 lds
    s_waitcnt vmcnt(16)
    s_barrier
    s_waitcnt vmcnt(8)
    s_barrier
    s_waitcnt vmcnt(0)
    s_barrier
    s_barrier
    s_endpgm
K1_DONE:
    s_endpgm

.section .rodata,"a"
.p2align 6
.amdhsa_kernel attn_k1_kernel
  .amdhsa_next_free_vgpr 256
  .amdhsa_next_free_sgpr 102
  .amdhsa_accum_offset 256
  .amdhsa_group_segment_fixed_size 0
  .amdhsa_kernarg_size 104
  .amdhsa_user_sgpr_count 2
  .amdhsa_user_sgpr_kernarg_segment_ptr 1
  .amdhsa_system_sgpr_workgroup_id_x 1
.end_amdhsa_kernel
```
